```python
import torch

def _softmax(x, axis=-1):
    return torch.softmax(x, dim=axis)

def _gelu(x):
    return torch.nn.functional.gelu(x, approximate='tanh')

def _silu(x):
    return torch.nn.functional.silu(x)

def _sigmoid(x):
    return torch.sigmoid(x)

def _layernorm(x, axis=-1, eps=1e-05):
    m = x.mean(dim=axis, keepdim=True)
    v = x.var(dim=axis, keepdim=True, unbiased=False)
    return (x - m) / torch.sqrt(v + eps)

def _scatter_add(tgt, idx, src, axis=0):
    return tgt.clone().index_add_(axis, idx, src)

def _segment_sum(src, seg, n):
    out = torch.zeros((n,) + src.shape[1:], dtype=src.dtype)
    return out.index_add_(0, seg, src)

def _pad(x, pw):
    flat = tuple((v for pair in reversed(pw) for v in pair))
    return torch.nn.functional.pad(x, flat)
kernel_name = 'adaLN_cond__sliding_block_cached__geglu_ffn__decode'

def setup_inputs():

    _w = lambda a: (lambda t: t.to(torch.bfloat16) if t.is_floating_point() else t)(torch.as_tensor(a))

    def _A_setup():
        B, Sq, D = (4, 1, 512)
        Hq, Hkv, Sk, Dh = (32, 8, 16384, 128)
        assert Hq % Hkv == 0, (Hq, Hkv)
        return {'x': _w((lambda *s: torch.randn(*s, dtype=torch.bfloat16) * 0.05)(B, Sq, D)), 'k_cache': _w((lambda *s: torch.randn(*s, dtype=torch.bfloat16) * 1.6)(B, Hkv, Sk, Dh)), 'v_cache': _w((lambda *s: torch.randn(*s, dtype=torch.bfloat16) * 1.6)(B, Hkv, Sk, Dh)), 'wq': _w((lambda *s: torch.randn(*s, dtype=torch.bfloat16) * 1.6)(D, Hq * Dh) * D ** (-0.5)), 'wo': _w((lambda *s: torch.randn(*s, dtype=torch.bfloat16) * 1.6)(Hq * Dh, D) * (Hq * Dh) ** (-0.5))}
    _A_in = _A_setup()

    def _B_setup():
        B, S, D, F = (4, 1, 512, 1792)
        return {'x': _w((lambda *s: torch.randn(*s, dtype=torch.bfloat16) * 0.05)(B, S, D)), 'w_gate': _w((lambda *s: torch.randn(*s, dtype=torch.bfloat16) * 0.05)(D, F)), 'w_up': _w((lambda *s: torch.randn(*s, dtype=torch.bfloat16) * 0.05)(D, F)), 'w_down': _w((lambda *s: torch.randn(*s, dtype=torch.bfloat16) * 0.05)(F, D))}
    _B_in = _B_setup()
    return {'A_x': _A_in['x'], 'A_k_cache': _A_in['k_cache'], 'A_v_cache': _A_in['v_cache'], 'A_wq': _A_in['wq'], 'A_wo': _A_in['wo'], 'B_x': _B_in['x'], 'B_w_gate': _B_in['w_gate'], 'B_w_up': _B_in['w_up'], 'B_w_down': _B_in['w_down'], 'c': _w((lambda *s: torch.randn(*s, dtype=torch.bfloat16) * 0.2)(4, 512) * 8.0), 'w_mod': _w((lambda *s: torch.randn(*s, dtype=torch.bfloat16) * 0.2)(512, 6 * 512) * 512 ** (-0.5) * 8.0)}

def reference(A_x, A_k_cache, A_v_cache, A_wq, A_wo, B_x, B_w_gate, B_w_up, B_w_down, c, w_mod):

    def _A_ref(x, k_cache, v_cache, wq, wo):
        B, Sq, D = x.shape
        Hq, Dh = (32, 128)
        Hkv, Sk = (k_cache.shape[1], k_cache.shape[2])
        W = min(4096, max(256, Sk // 4))
        rep = Hq // Hkv
        q = (lambda x, *d: x.permute(*d))((x @ wq).reshape(B, Sq, Hq, Dh), 0, 2, 1, 3)
        k = (lambda x, n, axis: torch.repeat_interleave(x, n, dim=axis))(k_cache[:, :, Sk - W:, :], rep, axis=1)
        v = (lambda x, n, axis: torch.repeat_interleave(x, n, dim=axis))(v_cache[:, :, Sk - W:, :], rep, axis=1)
        scores = torch.einsum('bhqd,bhkd->bhqk', q, k) * Dh ** (-0.5)
        p = _softmax(scores, axis=-1)
        o = torch.einsum('bhqk,bhkd->bhqd', p, v)
        return (lambda x, *d: x.permute(*d))(o, 0, 2, 1, 3).reshape(B, Sq, Hq * Dh) @ wo

    def _B_ref(x, w_gate, w_up, w_down):
        return _gelu(x @ w_gate) * (x @ w_up) @ w_down
    x = A_x
    mod = (_silu(c) @ w_mod).reshape(c.shape[0], 6, 1, -1)
    sa, ca, ga, sb, cb, gb = (mod[:, 0].clone(), mod[:, 1].clone(), mod[:, 2].clone(), mod[:, 3].clone(), mod[:, 4].clone(), mod[:, 5].clone())
    h = _layernorm(x, axis=-1) * (1 + ca) + sa
    x = x + ga * _A_ref(h, A_k_cache, A_v_cache, A_wq, A_wo)
    h = _layernorm(x, axis=-1) * (1 + cb) + sb
    x = x + gb * _B_ref(h, B_w_gate, B_w_up, B_w_down)
    return x
```

```asm
; @launch grid=(256,1,1) block=(768,1,1) lds=151552
.amdgcn_target "amdgcn-amd-amdhsa--gfx950"
.text
.globl adaLN_cond__sliding_block_cached__geglu_ffn__decode_kernel
.p2align 8
.type adaLN_cond__sliding_block_cached__geglu_ffn__decode_kernel,@function
adaLN_cond__sliding_block_cached__geglu_ffn__decode_kernel:
    s_cmp_ge_u32 s2, 256
    s_cbranch_scc1 L_end
    s_load_dwordx16 s[4:19], s[0:1], 0
    s_load_dwordx8 s[20:27], s[0:1], 64
    s_load_dwordx4 s[28:31], s[0:1], 96
    v_and_b32 v1, 63, v0
    v_lshrrev_b32 v2, 6, v0
    s_nop 0
    v_readfirstlane_b32 s3, v2
    s_and_b32 s72, s2, 7
    s_lshr_b32 s73, s2, 3
    s_and_b32 s74, s73, 3
    s_lshr_b32 s75, s73, 2
    s_add_u32 s77, s72, 1
    s_lshl_b32 s77, s77, 16
    s_mov_b64 s[92:93], -1
    s_mov_b32 s79, 0
    s_and_b32 s76, s3, 3
    s_cmp_ge_u32 s3, 8
    s_cbranch_scc1 L_v
    s_cmp_ge_u32 s3, 4
    s_cbranch_scc1 L_k
L_chain:
    s_setprio 2
    v_bfe_u32 v2, v1, 0, 2
    v_lshlrev_b32 v2, 10, v2
    v_bfe_u32 v4, v1, 2, 2
    v_lshl_add_u32 v2, v4, 6, v2
    v_bfe_u32 v4, v1, 4, 2
    v_lshl_add_u32 v2, v4, 4, v2
    v_bfe_u32 v3, v1, 2, 2
    v_lshlrev_b32 v3, 8, v3
    v_bfe_u32 v4, v1, 5, 1
    v_lshl_add_u32 v3, v4, 7, v3
    v_bfe_u32 v4, v1, 0, 2
    v_lshl_add_u32 v3, v4, 5, v3
    v_bfe_u32 v4, v1, 4, 1
    v_lshl_add_u32 v3, v4, 4, v3
    v_lshlrev_b32 v6, 3, v1
    v_lshlrev_b32 v8, 1, v1
    v_lshlrev_b32 v9, 2, v1
    v_bfe_u32 v11, v1, 0, 3
    v_lshlrev_b32 v11, 4, v11
    v_bfe_u32 v5, v1, 4, 1
    v_lshlrev_b32 v5, 5, v5
    v_xor_b32 v11, v11, v5
    v_lshrrev_b32 v10, 3, v1
    v_bfe_u32 v7, v1, 4, 2
    v_lshlrev_b32 v7, 10, v7
    v_bfe_u32 v4, v1, 2, 2
    v_lshl_add_u32 v7, v4, 7, v7
    v_bfe_u32 v4, v1, 0, 2
    v_lshl_add_u32 v7, v4, 3, v7
    v_bfe_u32 v4, v1, 3, 2
    v_lshl_add_u32 v7, v4, 5, v7
    s_cmp_ge_u32 s73, 16
    s_cbranch_scc1 L_chainA
    s_add_u32 s84, s76, 0
    s_and_b32 s84, s84, 3
    s_lshl_b32 s84, s84, 8
    s_add_u32 s85, s76, 1
    s_and_b32 s85, s85, 3
    s_lshl_b32 s85, s85, 8
    s_add_u32 s86, s76, 2
    s_and_b32 s86, s86, 3
    s_lshl_b32 s86, s86, 8
    s_add_u32 s87, s76, 3
    s_and_b32 s87, s87, 3
    s_lshl_b32 s87, s87, 8
    s_lshl_b32 s88, s76, 10
    s_lshl_b32 s89, s76, 14
    s_lshl_b32 s90, s76, 7
    s_cmp_lt_u32 s73, 4
    s_cbranch_scc1 B_mc
    s_sub_u32 s80, s73, 4
    s_cmp_lt_u32 s80, 8
    s_cbranch_scc1 B_isq
    s_lshl_b32 s80, s72, 2
    s_add_u32 s80, s80, s73
    s_add_u32 s80, s80, 4
    s_movk_i32 s56, 6144
    s_lshl_b32 s81, s80, 7
    s_lshl_b32 s57, s80, 9
    s_add_u32 s57, s57, s90
    s_add_u32 s57, s57, 0x2000
    s_mov_b32 s58, 1
    v_mov_b32 v14, v8
    s_waitcnt lgkmcnt(0)
    s_mov_b32 s40, s24
    s_mov_b32 s41, s25
    s_mov_b32 s42, 0x300000
    s_mov_b32 s43, 0x20000
    s_branch B_t64
B_isq:
    s_movk_i32 s56, 8192
    s_lshl_b32 s81, s72, 10
    s_lshl_b32 s82, s80, 7
    s_add_u32 s81, s81, s82
    s_lshl_b32 s57, s76, 5
    s_add_u32 s57, s57, s82
    s_add_u32 s57, s57, s77
    s_mov_b32 s58, 0
    v_bfe_u32 v14, v1, 4, 2
    v_lshlrev_b32 v14, 10, v14
    v_bfe_u32 v4, v1, 0, 4
    v_lshl_add_u32 v14, v4, 1, v14
    s_waitcnt lgkmcnt(0)
    s_mov_b32 s40, s10
    s_mov_b32 s41, s11
    s_mov_b32 s42, 0x400000
    s_mov_b32 s43, 0x20000
B_t64:
    s_mov_b32 s48, s4
    s_mov_b32 s49, s5
    s_mov_b32 s50, 0x1000
    s_mov_b32 s51, 0x20000
    s_mov_b32 s36, s22
    s_mov_b32 s37, s23
    s_mov_b32 s38, 0x1000
    s_mov_b32 s39, 0x20000
    v_mul_u32_u24 v10, s56, v10
    v_add_u32 v10, v10, v11
    v_xor_b32 v11, 64, v10
    s_mul_i32 s82, s90, s56
    s_add_u32 s81, s81, s82
    s_lshl_b32 s82, s56, 3
    buffer_load_dwordx4 v[164:167], v2, s[36:39], s84 offen
    buffer_load_dwordx4 v[16:19], v2, s[48:51], s84 offen
    buffer_load_dwordx4 v[20:23], v2, s[48:51], s85 offen
    buffer_load_dwordx4 v[24:27], v2, s[48:51], s86 offen
    buffer_load_dwordx4 v[28:31], v2, s[48:51], s87 offen
    s_add_u32 m0, s89, 0x5000
    s_nop 0
    buffer_load_dwordx4 v10, s[40:43], s81 offen nt lds
    s_add_u32 s81, s81, s82
    s_add_u32 m0, s89, 0x5400
    s_nop 0
    buffer_load_dwordx4 v11, s[40:43], s81 offen nt lds
    s_add_u32 s81, s81, s82
    s_add_u32 m0, s89, 0x5800
    s_nop 0
    buffer_load_dwordx4 v10, s[40:43], s81 offen nt lds
    s_add_u32 s81, s81, s82
    s_add_u32 m0, s89, 0x5c00
    s_nop 0
    buffer_load_dwordx4 v11, s[40:43], s81 offen nt lds
    s_add_u32 s81, s81, s82
    s_add_u32 m0, s89, 0x6000
    s_nop 0
    buffer_load_dwordx4 v10, s[40:43], s81 offen nt lds
    s_add_u32 s81, s81, s82
    s_add_u32 m0, s89, 0x6400
    s_nop 0
    buffer_load_dwordx4 v11, s[40:43], s81 offen nt lds
    s_add_u32 s81, s81, s82
    s_barrier
    s_mov_b32 s32, s30
    s_mov_b32 s33, s31
    s_mov_b32 s34, 0x800000
    s_mov_b32 s35, 0x20000
    s_bitcmp1_b32 s73, 0
    s_cbranch_scc1 GU_1
    s_mov_b32 s44, s16
    s_mov_b32 s45, s17
    s_mov_b32 s46, 0x1c0000
    s_mov_b32 s47, 0x20000
    s_branch GU_2
GU_1:
    s_mov_b32 s44, s18
    s_mov_b32 s45, s19
    s_mov_b32 s46, 0x1c0000
    s_mov_b32 s47, 0x20000
GU_2:
    s_nop 0
    s_bfe_u32 s83, s81, 0x30007
    s_cmp_eq_u32 s83, 3
    s_cbranch_scc1 B_dmx
B_dmn:
    s_waitcnt vmcnt(5)
    s_add_u32 m0, s89, 0x6800
    s_nop 0
    buffer_load_dwordx4 v10, s[40:43], s81 offen nt lds
    s_add_u32 s81, s81, s82
    s_waitcnt vmcnt(5)
    s_add_u32 m0, s89, 0x6c00
    s_nop 0
    buffer_load_dwordx4 v11, s[40:43], s81 offen nt lds
    s_add_u32 s81, s81, s82
    s_waitcnt vmcnt(5)
    s_add_u32 m0, s89, 0x7000
    s_nop 0
    buffer_load_dwordx4 v10, s[40:43], s81 offen nt lds
    s_add_u32 s81, s81, s82
    s_waitcnt vmcnt(5)
    s_add_u32 m0, s89, 0x7400
    s_nop 0
    buffer_load_dwordx4 v11, s[40:43], s81 offen nt lds
    s_add_u32 s81, s81, s82
    s_waitcnt vmcnt(5)
    s_add_u32 m0, s89, 0x7800
    s_nop 0
    buffer_load_dwordx4 v10, s[40:43], s81 offen nt lds
    s_add_u32 s81, s81, s82
    s_waitcnt vmcnt(5)
    s_add_u32 m0, s89, 0x7c00
    s_nop 0
    buffer_load_dwordx4 v11, s[40:43], s81 offen nt lds
    s_add_u32 s81, s81, s82
    s_waitcnt vmcnt(5)
    s_add_u32 m0, s89, 0x8000
    s_nop 0
    buffer_load_dwordx4 v10, s[40:43], s81 offen nt lds
    s_add_u32 s81, s81, s82
    s_waitcnt vmcnt(5)
    s_add_u32 m0, s89, 0x8400
    s_nop 0
    buffer_load_dwordx4 v11, s[40:43], s81 offen nt lds
    s_add_u32 s81, s81, s82
    s_waitcnt vmcnt(5)
    s_add_u32 m0, s89, 0x8800
    s_nop 0
    buffer_load_dwordx4 v10, s[40:43], s81 offen nt lds
    s_add_u32 s81, s81, s82
    s_waitcnt vmcnt(5)
    s_add_u32 m0, s89, 0x8c00
    s_nop 0
    buffer_load_dwordx4 v11, s[40:43], s81 offen nt lds
    s_lshl_b32 s91, s76, 2
    s_add_u32 s91, s91, 0x2e00
    v_mov_b32 v12, s91
    v_mov_b32 v13, 1
    ds_write_b32 v12, v13
    s_cmp_lt_u32 s73, 12
    s_cbranch_scc1 NG_3
    v_subrev_u32 v12, 416, v12
    ds_write_b32 v12, v13
NG_3:
    s_nop 0
    s_branch B_dmd
B_dmx:
    s_waitcnt vmcnt(5)
    s_add_u32 m0, s89, 0x6800
    s_nop 0
    buffer_load_dwordx4 v10, s[40:43], s81 offen nt lds
    s_add_u32 s81, s81, s82
    s_waitcnt vmcnt(5)
    s_add_u32 m0, s89, 0x6c00
    s_nop 0
    buffer_load_dwordx4 v11, s[40:43], s81 offen nt lds
    s_add_u32 s81, s81, s82
    s_waitcnt vmcnt(5)
    s_add_u32 m0, s89, 0x7000
    s_nop 0
    buffer_load_dwordx4 v10, s[40:43], s81 offen nt lds
    s_add_u32 s81, s81, s82
    s_waitcnt vmcnt(5)
    s_add_u32 m0, s89, 0x7400
    s_nop 0
    buffer_load_dwordx4 v11, s[40:43], s81 offen nt lds
    s_add_u32 s81, s81, s82
    s_waitcnt vmcnt(5)
    s_add_u32 m0, s89, 0x7800
    s_nop 0
    buffer_load_dwordx4 v10, s[40:43], s81 offen nt lds
    s_add_u32 s81, s81, s82
    s_waitcnt vmcnt(5)
    s_add_u32 m0, s89, 0x7c00
    s_nop 0
    buffer_load_dwordx4 v11, s[40:43], s81 offen nt lds
    s_add_u32 s81, s81, s82
    s_waitcnt vmcnt(5)
    s_add_u32 m0, s89, 0x8000
    s_nop 0
    buffer_load_dwordx4 v10, s[40:43], s81 offen nt lds
    s_add_u32 s81, s81, s82
    s_waitcnt vmcnt(5)
    s_add_u32 m0, s89, 0x8400
    s_nop 0
    buffer_load_dwordx4 v11, s[40:43], s81 offen nt lds
    s_add_u32 s81, s81, s82
    s_waitcnt vmcnt(5)
    s_add_u32 m0, s89, 0x8800
    s_nop 0
    buffer_load_dwordx4 v10, s[40:43], s81 offen nt lds
    s_add_u32 s81, s81, s82
    s_waitcnt vmcnt(5)
    s_add_u32 m0, s89, 0x8c00
    s_nop 0
    buffer_load_dwordx4 v11, s[40:43], s81 offen nt lds
    s_lshl_b32 s91, s76, 2
    s_add_u32 s91, s91, 0x2e00
    v_mov_b32 v12, s91
    v_mov_b32 v13, 1
    ds_write_b32 v12, v13
    s_cmp_lt_u32 s73, 12
    s_cbranch_scc1 NG_4
    v_subrev_u32 v12, 416, v12
    ds_write_b32 v12, v13
NG_4:
    s_nop 0
B_dmd:
    v_mov_b32 v160, 0x3f803f80
    v_mov_b32 v161, 0x3f803f80
    v_mov_b32 v162, 0x3f803f80
    v_mov_b32 v163, 0x3f803f80
    v_add_u32 v7, s89, v7
    s_waitcnt vmcnt(16)
    s_cmp_eq_u32 s58, 0
    s_cbranch_scc1 B_pq
    v_lshlrev_b32 v136, 16, v164
    v_and_b32 v137, 0xffff0000, v164
    v_lshlrev_b32 v138, 16, v165
    v_and_b32 v139, 0xffff0000, v165
    v_lshlrev_b32 v140, 16, v166
    v_and_b32 v141, 0xffff0000, v166
    v_lshlrev_b32 v142, 16, v167
    v_and_b32 v143, 0xffff0000, v167
    v_mul_f32 v144, 0xbfb8aa3b, v136
    v_mul_f32 v145, 0xbfb8aa3b, v137
    v_mul_f32 v146, 0xbfb8aa3b, v138
    v_mul_f32 v147, 0xbfb8aa3b, v139
    v_mul_f32 v148, 0xbfb8aa3b, v140
    v_mul_f32 v149, 0xbfb8aa3b, v141
    v_mul_f32 v150, 0xbfb8aa3b, v142
    v_mul_f32 v151, 0xbfb8aa3b, v143
    v_exp_f32 v144, v144
    v_exp_f32 v145, v145
    v_exp_f32 v146, v146
    v_exp_f32 v147, v147
    v_exp_f32 v148, v148
    v_exp_f32 v149, v149
    v_exp_f32 v150, v150
    v_exp_f32 v151, v151
    v_add_f32 v144, 1.0, v144
    v_add_f32 v145, 1.0, v145
    v_add_f32 v146, 1.0, v146
    v_add_f32 v147, 1.0, v147
    v_add_f32 v148, 1.0, v148
    v_add_f32 v149, 1.0, v149
    v_add_f32 v150, 1.0, v150
    v_add_f32 v151, 1.0, v151
    v_rcp_f32 v144, v144
    v_rcp_f32 v145, v145
    v_rcp_f32 v146, v146
    v_rcp_f32 v147, v147
    v_rcp_f32 v148, v148
    v_rcp_f32 v149, v149
    v_rcp_f32 v150, v150
    v_rcp_f32 v151, v151
    v_mul_f32 v136, v136, v144
    v_mul_f32 v137, v137, v145
    v_mul_f32 v138, v138, v146
    v_mul_f32 v139, v139, v147
    v_mul_f32 v140, v140, v148
    v_mul_f32 v141, v141, v149
    v_mul_f32 v142, v142, v150
    v_mul_f32 v143, v143, v151
    v_cvt_pk_bf16_f32 v164, v136, v137
    v_cvt_pk_bf16_f32 v165, v138, v139
    v_cvt_pk_bf16_f32 v166, v140, v141
    v_cvt_pk_bf16_f32 v167, v142, v143
    s_branch B_pd
B_pq:
    v_mfma_f32_16x16x32_bf16 v[32:35], v[160:163], v[16:19], 0
    v_mfma_f32_16x16x32_bf16 v[32:35], v[160:163], v[20:23], v[32:35]
    v_mfma_f32_16x16x32_bf16 v[32:35], v[160:163], v[24:27], v[32:35]
    v_mfma_f32_16x16x32_bf16 v[32:35], v[160:163], v[28:31], v[32:35]
    v_dot2_f32_bf16 v152, v16, v16, 0
    v_dot2_f32_bf16 v153, v17, v17, 0
    v_dot2_f32_bf16 v152, v18, v18, v152
    v_dot2_f32_bf16 v153, v19, v19, v153
    v_dot2_f32_bf16 v152, v20, v20, v152
    v_dot2_f32_bf16 v153, v21, v21, v153
    v_dot2_f32_bf16 v152, v22, v22, v152
    v_dot2_f32_bf16 v153, v23, v23, v153
    v_dot2_f32_bf16 v152, v24, v24, v152
    v_dot2_f32_bf16 v153, v25, v25, v153
    v_dot2_f32_bf16 v152, v26, v26, v152
    v_dot2_f32_bf16 v153, v27, v27, v153
    v_dot2_f32_bf16 v152, v28, v28, v152
    v_dot2_f32_bf16 v153, v29, v29, v153
    v_dot2_f32_bf16 v152, v30, v30, v152
    v_dot2_f32_bf16 v153, v31, v31, v153
    v_lshlrev_b32 v128, 16, v16
    v_and_b32 v129, 0xffff0000, v16
    v_lshlrev_b32 v130, 16, v17
    v_and_b32 v131, 0xffff0000, v17
    v_lshlrev_b32 v132, 16, v18
    v_and_b32 v133, 0xffff0000, v18
    v_lshlrev_b32 v134, 16, v19
    v_and_b32 v135, 0xffff0000, v19
    v_add_f32 v152, v152, v153
    v_add_f32_dpp v32, v32, v32 row_ror:4 row_mask:0xf bank_mask:0xf
    s_nop 1
    v_add_f32_dpp v32, v32, v32 row_ror:8 row_mask:0xf bank_mask:0xf
    v_add_f32_dpp v152, v152, v152 row_ror:4 row_mask:0xf bank_mask:0xf
    s_nop 1
    v_add_f32_dpp v152, v152, v152 row_ror:8 row_mask:0xf bank_mask:0xf
    v_mov_b32 v153, v152
    s_nop 1
    v_permlane32_swap_b32 v153, v152
    v_add_f32 v152, v152, v153
    v_mov_b32 v153, v152
    s_nop 1
    v_permlane16_swap_b32 v153, v152
    v_add_f32 v152, v152, v153
    v_mul_f32 v32, 0x3b000000, v32
    v_cvt_pk_bf16_f32 v154, 0, v32
    v_mul_f32 v33, v32, v32
    v_mul_f32 v152, 0x3b000000, v152
    v_sub_f32 v152, v152, v33
    v_max_f32 v152, 0, v152
    v_cvt_pk_bf16_f32 v152, 0, v152
    v_add_f32 v152, 0x3727c5ac, v152
    v_cvt_pk_bf16_f32 v152, 0, v152
    v_sqrt_f32 v152, v152
    v_pk_add_f32 v[128:129], v[128:129], v[154:155] op_sel_hi:[1,0] neg_lo:[0,1] neg_hi:[0,1]
    v_pk_add_f32 v[130:131], v[130:131], v[154:155] op_sel_hi:[1,0] neg_lo:[0,1] neg_hi:[0,1]
    v_pk_add_f32 v[132:133], v[132:133], v[154:155] op_sel_hi:[1,0] neg_lo:[0,1] neg_hi:[0,1]
    v_pk_add_f32 v[134:135], v[134:135], v[154:155] op_sel_hi:[1,0] neg_lo:[0,1] neg_hi:[0,1]
    v_cvt_pk_bf16_f32 v152, 0, v152
    v_rcp_f32 v156, v152
    v_cvt_pk_bf16_f32 v128, 0, v128
    v_cvt_pk_bf16_f32 v129, 0, v129
    v_cvt_pk_bf16_f32 v130, 0, v130
    v_cvt_pk_bf16_f32 v131, 0, v131
    v_cvt_pk_bf16_f32 v132, 0, v132
    v_cvt_pk_bf16_f32 v133, 0, v133
    v_cvt_pk_bf16_f32 v134, 0, v134
    v_cvt_pk_bf16_f32 v135, 0, v135
    v_pk_mul_f32 v[128:129], v[128:129], v[156:157] op_sel_hi:[1,0]
    v_pk_mul_f32 v[130:131], v[130:131], v[156:157] op_sel_hi:[1,0]
    v_pk_mul_f32 v[132:133], v[132:133], v[156:157] op_sel_hi:[1,0]
    v_pk_mul_f32 v[134:135], v[134:135], v[156:157] op_sel_hi:[1,0]
    v_cvt_pk_bf16_f32 v128, 0, v128
    v_cvt_pk_bf16_f32 v129, 0, v129
    v_cvt_pk_bf16_f32 v130, 0, v130
    v_cvt_pk_bf16_f32 v131, 0, v131
    v_cvt_pk_bf16_f32 v132, 0, v132
    v_cvt_pk_bf16_f32 v133, 0, v133
    v_cvt_pk_bf16_f32 v134, 0, v134
    v_cvt_pk_bf16_f32 v135, 0, v135
B_pd:
    s_waitcnt vmcnt(0)
    ds_read_b64_tr_b16 v[64:65], v7 offset:20480
    ds_read_b64_tr_b16 v[66:67], v7 offset:20992
    ds_read_b64_tr_b16 v[68:69], v7 offset:24576
    ds_read_b64_tr_b16 v[70:71], v7 offset:25088
    ds_read_b64_tr_b16 v[72:73], v7 offset:28672
    ds_read_b64_tr_b16 v[74:75], v7 offset:29184
    ds_read_b64_tr_b16 v[76:77], v7 offset:32768
    ds_read_b64_tr_b16 v[78:79], v7 offset:33280
    s_waitcnt lgkmcnt(0)
    v_xor_b32 v4, 32, v7
    ds_read_b64_tr_b16 v[80:81], v4 offset:20480
    ds_read_b64_tr_b16 v[82:83], v4 offset:20992
    ds_read_b64_tr_b16 v[84:85], v4 offset:24576
    ds_read_b64_tr_b16 v[86:87], v4 offset:25088
    ds_read_b64_tr_b16 v[88:89], v4 offset:28672
    ds_read_b64_tr_b16 v[90:91], v4 offset:29184
    ds_read_b64_tr_b16 v[92:93], v4 offset:32768
    ds_read_b64_tr_b16 v[94:95], v4 offset:33280
    s_waitcnt lgkmcnt(0)
    v_xor_b32 v4, 64, v7
    ds_read_b64_tr_b16 v[96:97], v4 offset:20480
    ds_read_b64_tr_b16 v[98:99], v4 offset:20992
    ds_read_b64_tr_b16 v[100:101], v4 offset:24576
    ds_read_b64_tr_b16 v[102:103], v4 offset:25088
    ds_read_b64_tr_b16 v[104:105], v4 offset:28672
    ds_read_b64_tr_b16 v[106:107], v4 offset:29184
    ds_read_b64_tr_b16 v[108:109], v4 offset:32768
    ds_read_b64_tr_b16 v[110:111], v4 offset:33280
    s_waitcnt lgkmcnt(0)
    v_xor_b32 v4, 96, v7
    ds_read_b64_tr_b16 v[112:113], v4 offset:20480
    ds_read_b64_tr_b16 v[114:115], v4 offset:20992
    ds_read_b64_tr_b16 v[116:117], v4 offset:24576
    ds_read_b64_tr_b16 v[118:119], v4 offset:25088
    ds_read_b64_tr_b16 v[120:121], v4 offset:28672
    ds_read_b64_tr_b16 v[122:123], v4 offset:29184
    ds_read_b64_tr_b16 v[124:125], v4 offset:32768
    ds_read_b64_tr_b16 v[126:127], v4 offset:33280
    s_waitcnt lgkmcnt(0)
    s_lshl_b32 s91, s76, 2
    s_add_u32 s91, s91, 0x2c40
    v_mov_b32 v12, s91
    v_mov_b32 v13, 1
    ds_write_b32 v12, v13
    s_cmp_lg_u32 s58, 0
    s_cbranch_scc1 B_mm
    v_mov_b32 v4, 0x2c70
    s_mov_b32 s78, 400000
P_7:
    ds_read_b32 v12, v4
    s_waitcnt lgkmcnt(0)
    v_cmp_eq_u32 vcc, -1, v12
    s_cbranch_vccz PD_6
    s_sub_u32 s78, s78, 1
    s_cbranch_scc0 P_7
PD_6:
    s_nop 0
    s_add_u32 s60, s88, 0x8000
    s_add_u32 s61, s88, 0xa000
    s_add_u32 s62, s88, 0xc000
    s_add_u32 s63, s88, 0xe000
    s_add_u32 s64, s88, 0x9000
    s_add_u32 s65, s88, 0xb000
    s_add_u32 s66, s88, 0xd000
    s_add_u32 s67, s88, 0xf000
    s_lshl_b32 s91, s76, 2
    v_mov_b32 v12, s91
    s_mov_b32 s78, 40000
P_10:
    buffer_load_dwordx4 v[16:19], v3, s[32:35], s60 offen sc1
    buffer_load_dwordx4 v[20:23], v3, s[32:35], s61 offen sc1
    buffer_load_dwordx4 v[24:27], v3, s[32:35], s62 offen sc1
    buffer_load_dwordx4 v[28:31], v3, s[32:35], s63 offen sc1
    buffer_load_dwordx4 v[32:35], v3, s[32:35], s64 offen sc1
    buffer_load_dwordx4 v[36:39], v3, s[32:35], s65 offen sc1
    buffer_load_dwordx4 v[40:43], v3, s[32:35], s66 offen sc1
    buffer_load_dwordx4 v[44:47], v3, s[32:35], s67 offen sc1
    ds_write_b32 v12, v12 offset:11808
    s_waitcnt vmcnt(0)
    v_max3_u32 v5, v16, v17, v18
    v_max3_u32 v5, v5, v19, v20
    v_max3_u32 v5, v5, v21, v22
    v_max3_u32 v5, v5, v23, v24
    v_max3_u32 v5, v5, v25, v26
    v_max3_u32 v5, v5, v27, v28
    v_max3_u32 v5, v5, v29, v30
    v_max3_u32 v5, v5, v31, v32
    v_max3_u32 v5, v5, v33, v34
    v_max3_u32 v5, v5, v35, v36
    v_max3_u32 v5, v5, v37, v38
    v_max3_u32 v5, v5, v39, v40
    v_max3_u32 v5, v5, v41, v42
    v_max3_u32 v5, v5, v43, v44
    v_max3_u32 v5, v5, v45, v46
    v_max_u32 v5, v5, v47
    v_cmp_eq_u32 vcc, -1, v5
    s_cbranch_vccz PD_9
    s_mov_b64 exec, vcc
    s_sub_u32 s78, s78, 1
    s_cbranch_scc0 P_10
PD_9:
    s_mov_b64 exec, s[92:93]
    v_pk_add_f32 v[144:145], v[32:33], v[40:41]
    v_pk_add_f32 v[146:147], v[34:35], v[42:43]
    v_pk_add_f32 v[148:149], v[36:37], v[44:45]
    v_pk_add_f32 v[150:151], v[38:39], v[46:47]
    v_pk_add_f32 v[136:137], v[16:17], v[24:25]
    v_pk_add_f32 v[138:139], v[18:19], v[26:27]
    v_pk_add_f32 v[140:141], v[20:21], v[28:29]
    v_pk_add_f32 v[142:143], v[22:23], v[30:31]
    v_cvt_pk_bf16_f32 v144, 0, v144
    v_cvt_pk_bf16_f32 v145, 0, v145
    v_cvt_pk_bf16_f32 v146, 0, v146
    v_cvt_pk_bf16_f32 v147, 0, v147
    v_cvt_pk_bf16_f32 v148, 0, v148
    v_cvt_pk_bf16_f32 v149, 0, v149
    v_cvt_pk_bf16_f32 v150, 0, v150
    v_cvt_pk_bf16_f32 v151, 0, v151
    v_add_f32 v144, 1.0, v144
    v_add_f32 v145, 1.0, v145
    v_add_f32 v146, 1.0, v146
    v_add_f32 v147, 1.0, v147
    v_add_f32 v148, 1.0, v148
    v_add_f32 v149, 1.0, v149
    v_add_f32 v150, 1.0, v150
    v_add_f32 v151, 1.0, v151
    v_cvt_pk_bf16_f32 v144, 0, v144
    v_cvt_pk_bf16_f32 v145, 0, v145
    v_cvt_pk_bf16_f32 v146, 0, v146
    v_cvt_pk_bf16_f32 v147, 0, v147
    v_cvt_pk_bf16_f32 v148, 0, v148
    v_cvt_pk_bf16_f32 v149, 0, v149
    v_cvt_pk_bf16_f32 v150, 0, v150
    v_cvt_pk_bf16_f32 v151, 0, v151
    v_cvt_pk_bf16_f32 v136, 0, v136
    v_cvt_pk_bf16_f32 v137, 0, v137
    v_cvt_pk_bf16_f32 v138, 0, v138
    v_cvt_pk_bf16_f32 v139, 0, v139
    v_cvt_pk_bf16_f32 v140, 0, v140
    v_cvt_pk_bf16_f32 v141, 0, v141
    v_cvt_pk_bf16_f32 v142, 0, v142
    v_cvt_pk_bf16_f32 v143, 0, v143
    v_pk_mul_f32 v[128:129], v[128:129], v[144:145]
    v_pk_mul_f32 v[130:131], v[130:131], v[146:147]
    v_pk_mul_f32 v[132:133], v[132:133], v[148:149]
    v_pk_mul_f32 v[134:135], v[134:135], v[150:151]
    v_cvt_pk_bf16_f32 v128, 0, v128
    v_cvt_pk_bf16_f32 v129, 0, v129
    v_cvt_pk_bf16_f32 v130, 0, v130
    v_cvt_pk_bf16_f32 v131, 0, v131
    v_cvt_pk_bf16_f32 v132, 0, v132
    v_cvt_pk_bf16_f32 v133, 0, v133
    v_cvt_pk_bf16_f32 v134, 0, v134
    v_cvt_pk_bf16_f32 v135, 0, v135
    v_pk_add_f32 v[128:129], v[128:129], v[136:137]
    v_pk_add_f32 v[130:131], v[130:131], v[138:139]
    v_pk_add_f32 v[132:133], v[132:133], v[140:141]
    v_pk_add_f32 v[134:135], v[134:135], v[142:143]
    v_cvt_pk_bf16_f32 v164, v128, v129
    v_cvt_pk_bf16_f32 v165, v130, v131
    v_cvt_pk_bf16_f32 v166, v132, v133
    v_cvt_pk_bf16_f32 v167, v134, v135
B_mm:
    s_nop 1
    v_mfma_f32_16x16x32_bf16 v[32:35], v[164:167], v[64:67], 0
    v_mfma_f32_16x16x32_bf16 v[36:39], v[164:167], v[68:71], 0
    v_mfma_f32_16x16x32_bf16 v[40:43], v[164:167], v[72:75], 0
    v_mfma_f32_16x16x32_bf16 v[44:47], v[164:167], v[76:79], 0
    v_mfma_f32_16x16x32_bf16 v[48:51], v[164:167], v[80:83], 0
    v_mfma_f32_16x16x32_bf16 v[52:55], v[164:167], v[84:87], 0
    v_mfma_f32_16x16x32_bf16 v[56:59], v[164:167], v[88:91], 0
    v_mfma_f32_16x16x32_bf16 v[60:63], v[164:167], v[92:95], 0
    v_mfma_f32_16x16x32_bf16 v[128:131], v[164:167], v[96:99], 0
    v_mfma_f32_16x16x32_bf16 v[132:135], v[164:167], v[100:103], 0
    v_mfma_f32_16x16x32_bf16 v[136:139], v[164:167], v[104:107], 0
    v_mfma_f32_16x16x32_bf16 v[140:143], v[164:167], v[108:111], 0
    v_mfma_f32_16x16x32_bf16 v[144:147], v[164:167], v[112:115], 0
    v_mfma_f32_16x16x32_bf16 v[148:151], v[164:167], v[116:119], 0
    v_mfma_f32_16x16x32_bf16 v[152:155], v[164:167], v[120:123], 0
    v_mfma_f32_16x16x32_bf16 v[156:159], v[164:167], v[124:127], 0
    v_add_u32 v4, s88, v9
    v_permlane16_swap_b32 v32, v33
    v_permlane16_swap_b32 v36, v37
    v_permlane16_swap_b32 v40, v41
    v_permlane16_swap_b32 v44, v45
    v_permlane16_swap_b32 v34, v35
    v_permlane16_swap_b32 v38, v39
    v_permlane16_swap_b32 v42, v43
    v_permlane16_swap_b32 v46, v47
    v_add_f32 v32, v32, v37
    v_add_f32 v34, v34, v39
    v_add_f32 v40, v40, v45
    v_add_f32 v42, v42, v47
    v_permlane32_swap_b32 v32, v34
    s_nop 0
    v_permlane32_swap_b32 v40, v42
    v_add_f32 v24, v32, v42
    ds_write_b32 v4, v24 offset:0
    v_permlane16_swap_b32 v48, v49
    v_permlane16_swap_b32 v52, v53
    v_permlane16_swap_b32 v56, v57
    v_permlane16_swap_b32 v60, v61
    v_permlane16_swap_b32 v50, v51
    v_permlane16_swap_b32 v54, v55
    v_permlane16_swap_b32 v58, v59
    v_permlane16_swap_b32 v62, v63
    v_add_f32 v48, v48, v53
    v_add_f32 v50, v50, v55
    v_add_f32 v56, v56, v61
    v_add_f32 v58, v58, v63
    v_permlane32_swap_b32 v48, v50
    s_nop 0
    v_permlane32_swap_b32 v56, v58
    v_add_f32 v25, v48, v58
    ds_write_b32 v4, v25 offset:256
    v_permlane16_swap_b32 v128, v129
    v_permlane16_swap_b32 v132, v133
    v_permlane16_swap_b32 v136, v137
    v_permlane16_swap_b32 v140, v141
    v_permlane16_swap_b32 v130, v131
    v_permlane16_swap_b32 v134, v135
    v_permlane16_swap_b32 v138, v139
    v_permlane16_swap_b32 v142, v143
    v_add_f32 v128, v128, v133
    v_add_f32 v130, v130, v135
    v_add_f32 v136, v136, v141
    v_add_f32 v138, v138, v143
    v_permlane32_swap_b32 v128, v130
    s_nop 0
    v_permlane32_swap_b32 v136, v138
    v_add_f32 v26, v128, v138
    ds_write_b32 v4, v26 offset:512
    v_permlane16_swap_b32 v144, v145
    v_permlane16_swap_b32 v148, v149
    v_permlane16_swap_b32 v152, v153
    v_permlane16_swap_b32 v156, v157
    v_permlane16_swap_b32 v146, v147
    v_permlane16_swap_b32 v150, v151
    v_permlane16_swap_b32 v154, v155
    v_permlane16_swap_b32 v158, v159
    v_add_f32 v144, v144, v149
    v_add_f32 v146, v146, v151
    v_add_f32 v152, v152, v157
    v_add_f32 v154, v154, v159
    v_permlane32_swap_b32 v144, v146
    s_nop 0
    v_permlane32_swap_b32 v152, v154
    v_add_f32 v27, v144, v154
    ds_write_b32 v4, v27 offset:768
    s_lshl_b32 s80, s76, 8
    v_add_u32 v4, s80, v9
    v_mov_b32 v5, 0x2c70
    s_mov_b32 s78, 400000
P_13:
    ds_read_b32 v24, v4 offset:0
    ds_read_b32 v25, v4 offset:1024
    ds_read_b32 v26, v4 offset:2048
    ds_read_b32 v27, v4 offset:3072
    ds_read_b32 v28, v5
    s_waitcnt lgkmcnt(0)
    v_max3_u32 v29, v24, v25, v26
    v_max3_u32 v29, v29, v27, v28
    v_cmp_eq_u32 vcc, -1, v29
    s_cbranch_vccz PD_12
    s_sub_u32 s78, s78, 1
    s_cbranch_scc0 P_13
PD_12:
    s_nop 0
    v_add_f32 v24, v24, v25
    v_add_f32 v26, v26, v27
    v_add_f32 v24, v24, v26
    s_nop 1
    v_mov_b32_dpp v29, v24 quad_perm:[1,0,3,2] row_mask:0xf bank_mask:0xf
    v_cvt_pk_bf16_f32 v28, v24, v29
    s_nop 1
    v_mov_b32_dpp v29, v28 row_shl:2 row_mask:0xf bank_mask:0xf
    v_mov_b32_dpp v30, v28 row_shl:4 row_mask:0xf bank_mask:0xf
    v_mov_b32_dpp v31, v28 row_shl:6 row_mask:0xf bank_mask:0xf
    s_mov_b32 exec_lo, 0x01010101
    s_mov_b32 exec_hi, 0x01010101
    s_cmp_lg_u32 s58, 0
    s_cbranch_scc1 B_pub
    s_add_u32 s80, s57, 0x6000
    buffer_store_dwordx4 v[28:31], v14, s[32:35], s80 offen
B_pub:
    buffer_store_dwordx4 v[28:31], v14, s[32:35], s57 offen sc1
    s_mov_b64 exec, -1
B_pubd:
    s_lshl_b32 s91, s76, 2
    s_add_u32 s91, s91, 0x2c60
    v_mov_b32 v12, s91
    v_mov_b32 v13, 1
    ds_write_b32 v12, v13
    s_branch B_post
B_mc:
    s_and_b32 s80, s73, 1
    s_lshl_b32 s81, s72, 1
    s_add_u32 s80, s80, s81
    s_lshr_b32 s82, s73, 1
    s_lshl_b32 s83, s82, 2
    s_add_u32 s83, s83, s76
    s_mul_i32 s81, s83, 393216
    s_lshl_b32 s56, s80, 7
    s_add_u32 s81, s81, s56
    s_lshl_b32 s83, s83, 7
    v_mul_u32_u24 v10, 0x1800, v10
    v_add_u32 v10, v10, v11
    v_xor_b32 v11, 64, v10
    s_waitcnt lgkmcnt(0)
    s_mov_b32 s40, s24
    s_mov_b32 s41, s25
    s_mov_b32 s42, 0x300000
    s_mov_b32 s43, 0x20000
    s_mov_b32 s36, s22
    s_mov_b32 s37, s23
    s_mov_b32 s38, 0x1000
    s_mov_b32 s39, 0x20000
    buffer_load_dwordx4 v[164:167], v2, s[36:39], s83 offen
    s_add_u32 m0, s89, 0x5000
    s_nop 0
    buffer_load_dwordx4 v10, s[40:43], s81 offen nt lds
    s_add_u32 s81, s81, 49152
    s_add_u32 m0, s89, 0x5400
    s_nop 0
    buffer_load_dwordx4 v11, s[40:43], s81 offen nt lds
    s_add_u32 s81, s81, 49152
    s_add_u32 m0, s89, 0x5800
    s_nop 0
    buffer_load_dwordx4 v10, s[40:43], s81 offen nt lds
    s_add_u32 s81, s81, 49152
    s_add_u32 m0, s89, 0x5c00
    s_nop 0
    buffer_load_dwordx4 v11, s[40:43], s81 offen nt lds
    s_add_u32 s81, s81, 49152
    s_add_u32 m0, s89, 0x6000
    s_nop 0
    buffer_load_dwordx4 v10, s[40:43], s81 offen nt lds
    s_add_u32 s81, s81, 49152
    s_add_u32 m0, s89, 0x6400
    s_nop 0
    buffer_load_dwordx4 v11, s[40:43], s81 offen nt lds
    s_add_u32 s81, s81, 49152
    s_barrier
    s_mov_b32 s32, s30
    s_mov_b32 s33, s31
    s_mov_b32 s34, 0x800000
    s_mov_b32 s35, 0x20000
    s_bitcmp1_b32 s73, 0
    s_cbranch_scc1 GU_14
    s_mov_b32 s44, s16
    s_mov_b32 s45, s17
    s_mov_b32 s46, 0x1c0000
    s_mov_b32 s47, 0x20000
    s_branch GU_15
GU_14:
    s_mov_b32 s44, s18
    s_mov_b32 s45, s19
    s_mov_b32 s46, 0x1c0000
    s_mov_b32 s47, 0x20000
GU_15:
    s_nop 0
    s_waitcnt vmcnt(5)
    s_add_u32 m0, s89, 0x6800
    s_nop 0
    buffer_load_dwordx4 v10, s[40:43], s81 offen nt lds
    s_add_u32 s81, s81, 49152
    s_waitcnt vmcnt(5)
    s_add_u32 m0, s89, 0x6c00
    s_nop 0
    buffer_load_dwordx4 v11, s[40:43], s81 offen nt lds
    s_lshl_b32 s91, s76, 2
    s_add_u32 s91, s91, 0x2e00
    v_mov_b32 v12, s91
    v_mov_b32 v13, 1
    ds_write_b32 v12, v13
    s_cmp_lt_u32 s73, 12
    s_cbranch_scc1 NG_16
    v_subrev_u32 v12, 416, v12
    ds_write_b32 v12, v13
NG_16:
    s_nop 0
    s_lshl_b32 s57, s80, 9
    s_add_u32 s57, s57, s90
    s_lshl_b32 s82, s82, 14
    s_add_u32 s57, s57, s82
    s_add_u32 s57, s57, 0x8000
    v_bfe_u32 v14, v1, 2, 1
    v_lshlrev_b32 v14, 13, v14
    v_bfe_u32 v4, v1, 4, 2
    v_lshl_add_u32 v14, v4, 5, v14
    v_bfe_u32 v4, v1, 3, 1
    v_lshl_add_u32 v14, v4, 4, v14
    v_mov_b32 v160, 0x3f803f80
    v_mov_b32 v161, 0x3f803f80
    v_mov_b32 v162, 0x3f803f80
    v_mov_b32 v163, 0x3f803f80
    v_add_u32 v7, s89, v7
    v_xor_b32 v17, 32, v7
    v_xor_b32 v18, 64, v7
    v_xor_b32 v19, 96, v7
    s_waitcnt vmcnt(8)
    v_lshlrev_b32 v136, 16, v164
    v_and_b32 v137, 0xffff0000, v164
    v_lshlrev_b32 v138, 16, v165
    v_and_b32 v139, 0xffff0000, v165
    v_lshlrev_b32 v140, 16, v166
    v_and_b32 v141, 0xffff0000, v166
    v_lshlrev_b32 v142, 16, v167
    v_and_b32 v143, 0xffff0000, v167
    v_mul_f32 v144, 0xbfb8aa3b, v136
    v_mul_f32 v145, 0xbfb8aa3b, v137
    v_mul_f32 v146, 0xbfb8aa3b, v138
    v_mul_f32 v147, 0xbfb8aa3b, v139
    v_mul_f32 v148, 0xbfb8aa3b, v140
    v_mul_f32 v149, 0xbfb8aa3b, v141
    v_mul_f32 v150, 0xbfb8aa3b, v142
    v_mul_f32 v151, 0xbfb8aa3b, v143
    v_exp_f32 v144, v144
    v_exp_f32 v145, v145
    v_exp_f32 v146, v146
    v_exp_f32 v147, v147
    v_exp_f32 v148, v148
    v_exp_f32 v149, v149
    v_exp_f32 v150, v150
    v_exp_f32 v151, v151
    v_add_f32 v144, 1.0, v144
    v_add_f32 v145, 1.0, v145
    v_add_f32 v146, 1.0, v146
    v_add_f32 v147, 1.0, v147
    v_add_f32 v148, 1.0, v148
    v_add_f32 v149, 1.0, v149
    v_add_f32 v150, 1.0, v150
    v_add_f32 v151, 1.0, v151
    v_rcp_f32 v144, v144
    v_rcp_f32 v145, v145
    v_rcp_f32 v146, v146
    v_rcp_f32 v147, v147
    v_rcp_f32 v148, v148
    v_rcp_f32 v149, v149
    v_rcp_f32 v150, v150
    v_rcp_f32 v151, v151
    v_mul_f32 v136, v136, v144
    v_mul_f32 v137, v137, v145
    v_mul_f32 v138, v138, v146
    v_mul_f32 v139, v139, v147
    v_mul_f32 v140, v140, v148
    v_mul_f32 v141, v141, v149
    v_mul_f32 v142, v142, v150
    v_mul_f32 v143, v143, v151
    v_cvt_pk_bf16_f32 v164, v136, v137
    v_cvt_pk_bf16_f32 v165, v138, v139
    v_cvt_pk_bf16_f32 v166, v140, v141
    v_cvt_pk_bf16_f32 v167, v142, v143
    v_add_u32 v4, s88, v9
    s_lshl_b32 s80, s76, 8
    v_add_u32 v15, s80, v9
    v_mov_b32 v5, 0x2c30
    s_waitcnt vmcnt(4)
    ds_read_b64_tr_b16 v[64:65], v7 offset:20480
    ds_read_b64_tr_b16 v[66:67], v7 offset:20992
    ds_read_b64_tr_b16 v[72:73], v17 offset:20480
    ds_read_b64_tr_b16 v[74:75], v17 offset:20992
    ds_read_b64_tr_b16 v[80:81], v18 offset:20480
    ds_read_b64_tr_b16 v[82:83], v18 offset:20992
    ds_read_b64_tr_b16 v[88:89], v19 offset:20480
    ds_read_b64_tr_b16 v[90:91], v19 offset:20992
    s_waitcnt vmcnt(0)
    ds_read_b64_tr_b16 v[68:69], v7 offset:24576
    ds_read_b64_tr_b16 v[70:71], v7 offset:25088
    ds_read_b64_tr_b16 v[76:77], v17 offset:24576
    ds_read_b64_tr_b16 v[78:79], v17 offset:25088
    ds_read_b64_tr_b16 v[84:85], v18 offset:24576
    ds_read_b64_tr_b16 v[86:87], v18 offset:25088
    ds_read_b64_tr_b16 v[92:93], v19 offset:24576
    ds_read_b64_tr_b16 v[94:95], v19 offset:25088
    s_waitcnt lgkmcnt(0)
    v_mfma_f32_16x16x32_bf16 v[32:35], v[164:167], v[64:67], 0
    v_mfma_f32_16x16x32_bf16 v[36:39], v[164:167], v[68:71], 0
    v_mfma_f32_16x16x32_bf16 v[40:43], v[164:167], v[72:75], 0
    v_mfma_f32_16x16x32_bf16 v[44:47], v[164:167], v[76:79], 0
    v_mfma_f32_16x16x32_bf16 v[48:51], v[164:167], v[80:83], 0
    v_mfma_f32_16x16x32_bf16 v[52:55], v[164:167], v[84:87], 0
    v_mfma_f32_16x16x32_bf16 v[56:59], v[164:167], v[88:91], 0
    v_mfma_f32_16x16x32_bf16 v[60:63], v[164:167], v[92:95], 0
    s_lshl_b32 s91, s76, 2
    s_add_u32 s91, s91, 0x2c40
    v_mov_b32 v12, s91
    v_mov_b32 v13, 1
    ds_write_b32 v12, v13
    v_permlane16_swap_b32 v32, v33
    v_permlane16_swap_b32 v36, v37
    v_permlane16_swap_b32 v34, v35
    v_permlane16_swap_b32 v38, v39
    v_add_f32 v32, v32, v37
    v_add_f32 v34, v34, v39
    s_nop 1
    v_permlane32_swap_b32 v32, v34
    ds_write_b32 v4, v32 offset:0
    v_permlane16_swap_b32 v40, v41
    v_permlane16_swap_b32 v44, v45
    v_permlane16_swap_b32 v42, v43
    v_permlane16_swap_b32 v46, v47
    v_add_f32 v40, v40, v45
    v_add_f32 v42, v42, v47
    s_nop 1
    v_permlane32_swap_b32 v40, v42
    ds_write_b32 v4, v40 offset:256
    v_permlane16_swap_b32 v48, v49
    v_permlane16_swap_b32 v52, v53
    v_permlane16_swap_b32 v50, v51
    v_permlane16_swap_b32 v54, v55
    v_add_f32 v48, v48, v53
    v_add_f32 v50, v50, v55
    s_nop 1
    v_permlane32_swap_b32 v48, v50
    ds_write_b32 v4, v48 offset:512
    v_permlane16_swap_b32 v56, v57
    v_permlane16_swap_b32 v60, v61
    v_permlane16_swap_b32 v58, v59
    v_permlane16_swap_b32 v62, v63
    v_add_f32 v56, v56, v61
    v_add_f32 v58, v58, v63
    s_nop 1
    v_permlane32_swap_b32 v56, v58
    ds_write_b32 v4, v56 offset:768
    s_mov_b32 s78, 400000
P_19:
    ds_read_b32 v24, v15 offset:0
    ds_read_b32 v25, v15 offset:1024
    ds_read_b32 v26, v15 offset:2048
    ds_read_b32 v27, v15 offset:3072
    ds_read_b32 v28, v5
    s_waitcnt lgkmcnt(0)
    v_max3_u32 v29, v24, v25, v26
    v_max3_u32 v29, v29, v27, v28
    v_cmp_eq_u32 vcc, -1, v29
    s_cbranch_vccz PD_18
    s_sub_u32 s78, s78, 1
    s_cbranch_scc0 P_19
PD_18:
    s_nop 0
    v_add_f32 v24, v24, v25
    v_add_f32 v26, v26, v27
    v_add_f32 v28, v24, v26
    s_nop 1
    v_mov_b32_dpp v29, v28 quad_perm:[1,1,1,1] row_mask:0xf bank_mask:0xf
    v_mov_b32_dpp v30, v28 quad_perm:[2,2,2,2] row_mask:0xf bank_mask:0xf
    v_mov_b32_dpp v31, v28 quad_perm:[3,3,3,3] row_mask:0xf bank_mask:0xf
    s_mov_b32 exec_lo, 0x11111111
    s_mov_b32 exec_hi, 0x11111111
    buffer_store_dwordx4 v[28:31], v14, s[32:35], s57 offen sc1
    s_mov_b64 exec, -1
    s_lshl_b32 s91, s76, 2
    s_add_u32 s91, s91, 0x2c60
    v_mov_b32 v12, s91
    v_mov_b32 v13, 1
    ds_write_b32 v12, v13
B_post:
    s_cmp_lg_u32 s76, 0
    s_cbranch_scc1 TB_back
    s_cmp_lt_u32 s73, 12
    s_cbranch_scc1 TB_back
    s_mov_b32 s58, 0
    s_mov_b32 s94, 0x0
    s_mov_b32 s95, 0x0
    s_mov_b64 s[92:93], 0
    s_mov_b64 exec, 0
    s_branch TB_body
TB_back:
    s_cmp_lg_u32 s76, 3
    s_cbranch_scc1 B_noq
    v_mov_b32 v4, 0x2c70
    s_mov_b32 s78, 400000
P_22:
    ds_read_b32 v12, v4
    s_waitcnt lgkmcnt(0)
    v_cmp_eq_u32 vcc, -1, v12
    s_cbranch_vccz PD_21
    s_sub_u32 s78, s78, 1
    s_cbranch_scc0 P_22
PD_21:
    s_nop 0
    v_lshlrev_b32 v4, 4, v1
    s_lshl_b32 s80, s74, 10
    s_add_u32 s80, s80, s77
    s_add_u32 s81, s80, 0x6000
    s_mov_b32 s78, 200
P_25:
    buffer_load_dwordx4 v[16:19], v4, s[32:35], s81 offen sc1
    s_waitcnt vmcnt(0)
    v_max3_u32 v5, v16, v17, v18
    v_max_u32 v5, v5, v19
    v_cmp_eq_u32 vcc, -1, v5
    s_cbranch_vccz PD_24
    s_mov_b64 exec, vcc
    s_sub_u32 s78, s78, 1
    s_cbranch_scc0 P_25
    s_mov_b32 s78, 40000
P_26:
    buffer_load_dwordx4 v[16:19], v4, s[32:35], s80 offen offset:0 sc1
    s_waitcnt vmcnt(0)
    v_max3_u32 v5, v16, v17, v18
    v_max_u32 v5, v5, v19
    v_cmp_eq_u32 vcc, -1, v5
    s_cbranch_vccz PD_24
    s_mov_b64 exec, vcc
    s_sub_u32 s78, s78, 1
    s_cbranch_scc0 P_26
PD_24:
    s_mov_b64 exec, s[92:93]
    ds_write_b128 v4, v[16:19] offset:6144
    s_waitcnt vmcnt(0)
B_noq:
    v_mov_b32 v4, 0x2c70
    s_mov_b32 s78, 400000
P_29:
    ds_read_b32 v12, v4
    s_waitcnt lgkmcnt(0)
    v_cmp_eq_u32 vcc, -1, v12
    s_cbranch_vccz PD_28
    s_sub_u32 s78, s78, 1
    s_cbranch_scc0 P_29
PD_28:
    s_nop 0
    s_lshl_b32 s91, s76, 2
    s_add_u32 s91, s91, 0x2c00
    v_mov_b32 v4, s91
    s_mov_b32 s78, 400000
P_32:
    ds_read_b32 v12, v4
    s_waitcnt lgkmcnt(0)
    v_cmp_eq_u32 vcc, -1, v12
    s_cbranch_vccz PD_31
    s_sub_u32 s78, s78, 1
    s_cbranch_scc0 P_32
PD_31:
    s_nop 0
    s_cmp_lg_u32 s76, 2
    s_cbranch_scc1 B_nox2
    s_getreg_b32 s81, hwreg(HW_REG_XCC_ID)
    s_and_b32 s81, s81, 0xf
    s_add_u32 s80, s77, 0x1400
    v_bfe_u32 v4, v1, 0, 5
    v_lshlrev_b32 v4, 2, v4
    s_mov_b32 s78, 40000
P_35:
    buffer_load_dword v20, v4, s[32:35], s80 offen sc1
    s_waitcnt vmcnt(0)
    v_cmp_eq_u32 vcc, -1, v20
    s_cbranch_vccz PD_34
    s_mov_b64 exec, vcc
    s_sub_u32 s78, s78, 1
    s_cbranch_scc0 P_35
PD_34:
    s_mov_b64 exec, s[92:93]
    v_cmp_ne_u32 vcc, s81, v20
    s_cmp_eq_u32 vcc_lo, 0
    s_cselect_b32 s79, 1, 0
    v_mov_b32 v20, s79
    v_mov_b32 v4, 0x2c74
    ds_write_b32 v4, v20
B_nox2:
    s_add_u32 s80, s88, 20480
    s_add_u32 s81, s88, 24576
    s_mov_b32 s78, 40000
P_38:
    buffer_load_dwordx4 v[16:19], v3, s[32:35], s80 offen sc1
    buffer_load_dwordx4 v[20:23], v3, s[32:35], s81 offen sc1
    s_waitcnt vmcnt(0)
    v_max3_u32 v5, v16, v17, v18
    v_max3_u32 v5, v5, v19, v20
    v_max3_u32 v5, v5, v21, v22
    v_max_u32 v5, v5, v23
    v_cmp_eq_u32 vcc, -1, v5
    s_cbranch_vccz PD_37
    s_mov_b64 exec, vcc
    s_sub_u32 s78, s78, 1
    s_cbranch_scc0 P_38
PD_37:
    s_mov_b64 exec, s[92:93]
    v_lshlrev_b32 v144, 16, v20
    v_and_b32 v145, 0xffff0000, v20
    v_lshlrev_b32 v146, 16, v21
    v_and_b32 v147, 0xffff0000, v21
    v_lshlrev_b32 v148, 16, v22
    v_and_b32 v149, 0xffff0000, v22
    v_lshlrev_b32 v150, 16, v23
    v_and_b32 v151, 0xffff0000, v23
    v_lshlrev_b32 v136, 16, v16
    v_and_b32 v137, 0xffff0000, v16
    v_lshlrev_b32 v138, 16, v17
    v_and_b32 v139, 0xffff0000, v17
    v_lshlrev_b32 v140, 16, v18
    v_and_b32 v141, 0xffff0000, v18
    v_lshlrev_b32 v142, 16, v19
    v_and_b32 v143, 0xffff0000, v19
    v_add_f32 v144, 1.0, v144
    v_add_f32 v145, 1.0, v145
    v_add_f32 v146, 1.0, v146
    v_add_f32 v147, 1.0, v147
    v_add_f32 v148, 1.0, v148
    v_add_f32 v149, 1.0, v149
    v_add_f32 v150, 1.0, v150
    v_add_f32 v151, 1.0, v151
    v_cvt_pk_bf16_f32 v144, 0, v144
    v_cvt_pk_bf16_f32 v145, 0, v145
    v_cvt_pk_bf16_f32 v146, 0, v146
    v_cvt_pk_bf16_f32 v147, 0, v147
    v_cvt_pk_bf16_f32 v148, 0, v148
    v_cvt_pk_bf16_f32 v149, 0, v149
    v_cvt_pk_bf16_f32 v150, 0, v150
    v_cvt_pk_bf16_f32 v151, 0, v151
    v_mov_b32 v4, 0x2c74
    s_mov_b32 s78, 400000
P_41:
    ds_read_b32 v12, v4
    s_waitcnt lgkmcnt(0)
    v_cmp_eq_u32 vcc, -1, v12
    s_cbranch_vccz PD_40
    s_sub_u32 s78, s78, 1
    s_cbranch_scc0 P_41
PD_40:
    s_nop 0
    v_readfirstlane_b32 s79, v12
    v_bfe_u32 v10, v1, 4, 2
    v_lshlrev_b32 v10, 3, v10
    v_bfe_u32 v4, v1, 2, 2
    v_lshl_add_u32 v10, v4, 0, v10
    v_mul_u32_u24 v10, 0xe00, v10
    v_bfe_u32 v11, v1, 0, 2
    v_lshlrev_b32 v11, 4, v11
    v_bfe_u32 v5, v1, 4, 1
    v_lshlrev_b32 v5, 5, v5
    v_xor_b32 v11, v11, v5
    v_add_u32 v10, v10, v11
    v_bfe_u32 v7, v1, 2, 4
    v_lshlrev_b32 v7, 6, v7
    v_bfe_u32 v4, v1, 4, 1
    v_lshl_add_u32 v7, v4, 5, v7
    v_bfe_u32 v4, v1, 0, 2
    v_lshl_add_u32 v7, v4, 3, v7
    v_add_u32 v7, s89, v7
    v_xor_b32 v11, 32, v7
    s_mul_i32 s81, s76, 458752
    s_mul_i32 s82, s72, 448
    s_add_u32 s81, s81, s82
    s_lshr_b32 s83, s73, 1
    s_lshl_b32 s82, s83, 6
    s_add_u32 s56, s81, s82
    s_lshl_b32 s57, s83, 8
    s_and_b32 s58, s73, 1
    s_lshl_b32 s82, s58, 11
    s_add_u32 s57, s57, s82
    s_add_u32 s57, s57, s77
    s_add_u32 s57, s57, 0x4000
    s_lshl_b32 s84, s84, 2
    s_add_u32 s84, s84, s77
    s_add_u32 s84, s84, 0x3000
    s_lshl_b32 s85, s85, 2
    s_add_u32 s85, s85, s77
    s_add_u32 s85, s85, 0x3000
    s_lshl_b32 s86, s86, 2
    s_add_u32 s86, s86, s77
    s_add_u32 s86, s86, 0x3000
    s_lshl_b32 s87, s87, 2
    s_add_u32 s87, s87, s77
    s_add_u32 s87, s87, 0x3000
    s_lshl_b32 s90, s76, 9
    v_add_u32 v9, s90, v6
    s_mov_b32 s94, 0x55555555
    s_mov_b32 s95, 0x55555555
    s_lshl_b32 s59, s72, 5
    s_lshl_b32 s91, s74, 3
    s_add_u32 s59, s59, s91
    s_add_u32 s59, s59, s75
    s_lshl_b32 s59, s59, 2
    s_add_u32 s59, s59, s76
    s_lshl_b32 s59, s59, 9
    s_add_u32 s59, s59, 0x100000
    s_lshl_b32 s91, s76, 9
    v_add_u32 v13, s91, v6
TB_real:
    v_bfe_u32 v4, v1, 0, 1
    v_lshlrev_b32 v4, 3, v4
    s_mov_b32 s78, 400000
P_44:
    ds_read_b64 v[24:25], v4 offset:11520
    ds_read_b64 v[26:27], v4 offset:11536
    ds_read_b64 v[28:29], v4 offset:11552
    ds_read_b64 v[30:31], v4 offset:11568
    s_waitcnt lgkmcnt(0)
    v_max3_u32 v5, v24, v25, v26
    v_max3_u32 v5, v5, v27, v28
    v_max3_u32 v5, v5, v29, v30
    v_max_u32 v5, v5, v31
    v_cmp_eq_u32 vcc, -1, v5
    s_cbranch_vccz PD_43
    s_sub_u32 s78, s78, 1
    s_cbranch_scc0 P_44
PD_43:
    s_nop 0
    s_mov_b32 s78, 400000
P_47:
    ds_read_b64 v[16:17], v13 offset:12288
    ds_read_b64 v[18:19], v13 offset:14336
    ds_read_b64 v[20:21], v13 offset:16384
    ds_read_b64 v[22:23], v13 offset:18432
    s_waitcnt lgkmcnt(0)
    v_max3_u32 v5, v16, v17, v18
    v_max3_u32 v5, v5, v19, v20
    v_max3_u32 v5, v5, v21, v22
    v_max_u32 v5, v5, v23
    v_cmp_eq_u32 vcc, -1, v5
    s_cbranch_vccz PD_46
    s_sub_u32 s78, s78, 1
    s_cbranch_scc0 P_47
PD_46:
    s_nop 0
    v_pk_mul_f32 v[16:17], v[16:17], v[24:25]
    v_pk_mul_f32 v[20:21], v[20:21], v[28:29]
    v_pk_fma_f32 v[16:17], v[18:19], v[26:27], v[16:17]
    v_pk_fma_f32 v[20:21], v[22:23], v[30:31], v[20:21]
    v_pk_add_f32 v[16:17], v[16:17], v[20:21]
    s_cmp_eq_u32 s79, 1
    s_cbranch_scc0 SLOW_48
    buffer_store_dwordx2 v[16:17], v6, s[32:35], s59 offen
BACK_49:
    s_nop 0
    s_cmp_ge_u32 s73, 14
    s_cbranch_scc1 L_fin
    s_waitcnt vmcnt(0)
    s_add_u32 s81, s56, 0x0
    s_add_u32 m0, s89, 0x5000
    s_nop 0
    buffer_load_dwordx4 v10, s[44:47], s81 offen nt lds
    s_add_u32 s81, s56, 0x3800
    s_add_u32 m0, s89, 0x5400
    s_nop 0
    buffer_load_dwordx4 v10, s[44:47], s81 offen nt lds
    s_add_u32 s81, s56, 0x1c000
    s_add_u32 m0, s89, 0x5800
    s_nop 0
    buffer_load_dwordx4 v10, s[44:47], s81 offen nt lds
    s_add_u32 s81, s56, 0x1f800
    s_add_u32 m0, s89, 0x5c00
    s_nop 0
    buffer_load_dwordx4 v10, s[44:47], s81 offen nt lds
    s_add_u32 s81, s56, 0x38000
    s_add_u32 m0, s89, 0x6000
    s_nop 0
    buffer_load_dwordx4 v10, s[44:47], s81 offen nt lds
    s_add_u32 s81, s56, 0x3b800
    s_add_u32 m0, s89, 0x6400
    s_nop 0
    buffer_load_dwordx4 v10, s[44:47], s81 offen nt lds
    s_add_u32 s81, s56, 0x54000
    s_add_u32 m0, s89, 0x6800
    s_nop 0
    buffer_load_dwordx4 v10, s[44:47], s81 offen nt lds
    s_add_u32 s81, s56, 0x57800
    s_add_u32 m0, s89, 0x6c00
    s_nop 0
    buffer_load_dwordx4 v10, s[44:47], s81 offen nt lds
    s_waitcnt vmcnt(0)
    ds_read_b64_tr_b16 v[64:65], v7 offset:20480
    ds_read_b64_tr_b16 v[66:67], v7 offset:21504
    ds_read_b64_tr_b16 v[68:69], v7 offset:22528
    ds_read_b64_tr_b16 v[70:71], v7 offset:23552
    ds_read_b64_tr_b16 v[72:73], v7 offset:24576
    ds_read_b64_tr_b16 v[74:75], v7 offset:25600
    ds_read_b64_tr_b16 v[76:77], v7 offset:26624
    ds_read_b64_tr_b16 v[78:79], v7 offset:27648
    s_waitcnt lgkmcnt(0)
    ds_read_b64_tr_b16 v[80:81], v11 offset:20480
    ds_read_b64_tr_b16 v[82:83], v11 offset:21504
    ds_read_b64_tr_b16 v[84:85], v11 offset:22528
    ds_read_b64_tr_b16 v[86:87], v11 offset:23552
    ds_read_b64_tr_b16 v[88:89], v11 offset:24576
    ds_read_b64_tr_b16 v[90:91], v11 offset:25600
    ds_read_b64_tr_b16 v[92:93], v11 offset:26624
    ds_read_b64_tr_b16 v[94:95], v11 offset:27648
    s_waitcnt lgkmcnt(0)
TB_body:
    s_mov_b32 s78, 80000
X1_r:
    s_lshr_b32 s78, s78, 1
    s_mov_b64 s[36:37], s[92:93]
    s_mov_b64 s[38:39], s[92:93]
    s_mov_b64 s[40:41], s[92:93]
    s_mov_b64 s[42:43], s[92:93]
X1_l:
    s_mov_b64 exec, s[36:37]
    buffer_load_dwordx4 v[16:19], v3, s[32:35], s84 offen sc1
    s_mov_b64 exec, s[38:39]
    buffer_load_dwordx4 v[20:23], v3, s[32:35], s85 offen sc1
    s_mov_b64 exec, s[40:41]
    buffer_load_dwordx4 v[24:27], v3, s[32:35], s86 offen sc1
    s_mov_b64 exec, s[42:43]
    buffer_load_dwordx4 v[28:31], v3, s[32:35], s87 offen sc1
    s_mov_b64 exec, s[92:93]
    s_sub_u32 s78, s78, 1
    s_cselect_b64 s[96:97], 0, -1
    s_waitcnt vmcnt(0)
    v_cmp_eq_u32 s[36:37], -1, v16
    v_cmp_eq_u32 s[38:39], -1, v20
    v_cmp_eq_u32 s[40:41], -1, v24
    v_cmp_eq_u32 s[42:43], -1, v28
    s_or_b64 vcc, s[36:37], s[38:39]
    s_or_b64 s[98:99], s[40:41], s[42:43]
    s_or_b64 vcc, vcc, s[98:99]
    s_and_b64 vcc, vcc, s[96:97]
    s_cbranch_scc1 X1_l
    v_mfma_f32_16x16x32_bf16 v[32:35], v[160:163], v[16:19], 0
    v_mfma_f32_16x16x32_bf16 v[32:35], v[160:163], v[20:23], v[32:35]
    v_mfma_f32_16x16x32_bf16 v[32:35], v[160:163], v[24:27], v[32:35]
    v_mfma_f32_16x16x32_bf16 v[32:35], v[160:163], v[28:31], v[32:35]
    v_dot2_f32_bf16 v152, v16, v16, 0
    v_dot2_f32_bf16 v153, v17, v17, 0
    v_dot2_f32_bf16 v152, v18, v18, v152
    v_dot2_f32_bf16 v153, v19, v19, v153
    v_dot2_f32_bf16 v152, v20, v20, v152
    v_dot2_f32_bf16 v153, v21, v21, v153
    v_dot2_f32_bf16 v152, v22, v22, v152
    v_dot2_f32_bf16 v153, v23, v23, v153
    v_dot2_f32_bf16 v152, v24, v24, v152
    v_dot2_f32_bf16 v153, v25, v25, v153
    v_dot2_f32_bf16 v152, v26, v26, v152
    v_dot2_f32_bf16 v153, v27, v27, v153
    v_dot2_f32_bf16 v152, v28, v28, v152
    v_dot2_f32_bf16 v153, v29, v29, v153
    v_dot2_f32_bf16 v152, v30, v30, v152
    v_dot2_f32_bf16 v153, v31, v31, v153
    v_lshlrev_b32 v128, 16, v16
    v_and_b32 v129, 0xffff0000, v16
    v_lshlrev_b32 v130, 16, v17
    v_and_b32 v131, 0xffff0000, v17
    v_lshlrev_b32 v132, 16, v18
    v_and_b32 v133, 0xffff0000, v18
    v_lshlrev_b32 v134, 16, v19
    v_and_b32 v135, 0xffff0000, v19
    v_add_f32 v152, v152, v153
    v_add_f32_dpp v32, v32, v32 row_ror:4 row_mask:0xf bank_mask:0xf
    s_nop 1
    v_add_f32_dpp v32, v32, v32 row_ror:8 row_mask:0xf bank_mask:0xf
    v_add_f32_dpp v152, v152, v152 row_ror:4 row_mask:0xf bank_mask:0xf
    s_nop 1
    v_add_f32_dpp v152, v152, v152 row_ror:8 row_mask:0xf bank_mask:0xf
    v_mov_b32 v153, v152
    s_nop 1
    v_permlane32_swap_b32 v153, v152
    v_add_f32 v152, v152, v153
    v_mov_b32 v153, v152
    s_nop 1
    v_permlane16_swap_b32 v153, v152
    v_add_f32 v152, v152, v153
    v_mul_f32 v32, 0x3b000000, v32
    v_cvt_pk_bf16_f32 v154, 0, v32
    v_mul_f32 v33, v32, v32
    v_mul_f32 v152, 0x3b000000, v152
    v_sub_f32 v152, v152, v33
    v_cmp_u_f32 vcc, v152, v152
    v_max_f32 v152, 0, v152
    v_cvt_pk_bf16_f32 v152, 0, v152
    v_add_f32 v152, 0x3727c5ac, v152
    v_cvt_pk_bf16_f32 v152, 0, v152
    v_sqrt_f32 v152, v152
    v_pk_add_f32 v[128:129], v[128:129], v[154:155] op_sel_hi:[1,0] neg_lo:[0,1] neg_hi:[0,1]
    v_pk_add_f32 v[130:131], v[130:131], v[154:155] op_sel_hi:[1,0] neg_lo:[0,1] neg_hi:[0,1]
    v_pk_add_f32 v[132:133], v[132:133], v[154:155] op_sel_hi:[1,0] neg_lo:[0,1] neg_hi:[0,1]
    v_pk_add_f32 v[134:135], v[134:135], v[154:155] op_sel_hi:[1,0] neg_lo:[0,1] neg_hi:[0,1]
    v_cvt_pk_bf16_f32 v152, 0, v152
    v_rcp_f32 v156, v152
    v_cvt_pk_bf16_f32 v128, 0, v128
    v_cvt_pk_bf16_f32 v129, 0, v129
    v_cvt_pk_bf16_f32 v130, 0, v130
    v_cvt_pk_bf16_f32 v131, 0, v131
    v_cvt_pk_bf16_f32 v132, 0, v132
    v_cvt_pk_bf16_f32 v133, 0, v133
    v_cvt_pk_bf16_f32 v134, 0, v134
    v_cvt_pk_bf16_f32 v135, 0, v135
    v_pk_mul_f32 v[128:129], v[128:129], v[156:157] op_sel_hi:[1,0]
    v_pk_mul_f32 v[130:131], v[130:131], v[156:157] op_sel_hi:[1,0]
    v_pk_mul_f32 v[132:133], v[132:133], v[156:157] op_sel_hi:[1,0]
    v_pk_mul_f32 v[134:135], v[134:135], v[156:157] op_sel_hi:[1,0]
    v_cvt_pk_bf16_f32 v128, 0, v128
    v_cvt_pk_bf16_f32 v129, 0, v129
    v_cvt_pk_bf16_f32 v130, 0, v130
    v_cvt_pk_bf16_f32 v131, 0, v131
    v_cvt_pk_bf16_f32 v132, 0, v132
    v_cvt_pk_bf16_f32 v133, 0, v133
    v_cvt_pk_bf16_f32 v134, 0, v134
    v_cvt_pk_bf16_f32 v135, 0, v135
    s_and_b64 vcc, vcc, s[96:97]
    s_cbranch_scc1 X1_r
    s_waitcnt vmcnt(0)
    v_pk_mul_f32 v[128:129], v[128:129], v[144:145]
    v_pk_mul_f32 v[130:131], v[130:131], v[146:147]
    v_pk_mul_f32 v[132:133], v[132:133], v[148:149]
    v_pk_mul_f32 v[134:135], v[134:135], v[150:151]
    v_cvt_pk_bf16_f32 v128, 0, v128
    v_cvt_pk_bf16_f32 v129, 0, v129
    v_cvt_pk_bf16_f32 v130, 0, v130
    v_cvt_pk_bf16_f32 v131, 0, v131
    v_cvt_pk_bf16_f32 v132, 0, v132
    v_cvt_pk_bf16_f32 v133, 0, v133
    v_cvt_pk_bf16_f32 v134, 0, v134
    v_cvt_pk_bf16_f32 v135, 0, v135
    v_pk_add_f32 v[128:129], v[128:129], v[136:137]
    v_pk_add_f32 v[130:131], v[130:131], v[138:139]
    v_pk_add_f32 v[132:133], v[132:133], v[140:141]
    v_pk_add_f32 v[134:135], v[134:135], v[142:143]
    v_cvt_pk_bf16_f32 v16, v128, v129
    v_cvt_pk_bf16_f32 v17, v130, v131
    v_cvt_pk_bf16_f32 v18, v132, v133
    v_cvt_pk_bf16_f32 v19, v134, v135
    s_nop 1
    v_mfma_f32_16x16x32_bf16 v[32:35], v[16:19], v[64:67], 0
    v_mfma_f32_16x16x32_bf16 v[36:39], v[16:19], v[68:71], 0
    v_mfma_f32_16x16x32_bf16 v[40:43], v[16:19], v[72:75], 0
    v_mfma_f32_16x16x32_bf16 v[44:47], v[16:19], v[76:79], 0
    v_mfma_f32_16x16x32_bf16 v[48:51], v[16:19], v[80:83], 0
    v_mfma_f32_16x16x32_bf16 v[52:55], v[16:19], v[84:87], 0
    v_mfma_f32_16x16x32_bf16 v[56:59], v[16:19], v[88:91], 0
    v_mfma_f32_16x16x32_bf16 v[60:63], v[16:19], v[92:95], 0
    s_nop 0
    v_permlane16_swap_b32 v32, v33
    v_permlane16_swap_b32 v36, v37
    v_permlane16_swap_b32 v40, v41
    v_permlane16_swap_b32 v44, v45
    v_permlane16_swap_b32 v34, v35
    v_permlane16_swap_b32 v38, v39
    v_permlane16_swap_b32 v42, v43
    v_permlane16_swap_b32 v46, v47
    v_add_f32 v32, v32, v37
    v_add_f32 v34, v34, v39
    v_add_f32 v40, v40, v45
    v_add_f32 v42, v42, v47
    v_permlane32_swap_b32 v32, v34
    s_nop 0
    v_permlane32_swap_b32 v40, v42
    v_add_f32 v24, v32, v42
    v_permlane16_swap_b32 v48, v49
    v_permlane16_swap_b32 v52, v53
    v_permlane16_swap_b32 v56, v57
    v_permlane16_swap_b32 v60, v61
    v_permlane16_swap_b32 v50, v51
    v_permlane16_swap_b32 v54, v55
    v_permlane16_swap_b32 v58, v59
    v_permlane16_swap_b32 v62, v63
    v_add_f32 v48, v48, v53
    v_add_f32 v50, v50, v55
    v_add_f32 v56, v56, v61
    v_add_f32 v58, v58, v63
    v_permlane32_swap_b32 v48, v50
    s_nop 0
    v_permlane32_swap_b32 v56, v58
    v_add_f32 v25, v48, v58
    s_cmp_eq_u32 s76, 0
    s_cbranch_scc1 B_g0
    ds_write_b64 v9, v[24:25] offset:4096
    s_branch TB_end
B_g0:
    s_mov_b32 s78, 400000
P_52:
    ds_read_b64 v[26:27], v6 offset:4608
    ds_read_b64 v[28:29], v6 offset:5120
    ds_read_b64 v[30:31], v6 offset:5632
    s_waitcnt lgkmcnt(0)
    v_max3_u32 v5, v26, v27, v28
    v_max3_u32 v5, v5, v29, v30
    v_max_u32 v5, v5, v31
    v_cmp_eq_u32 vcc, -1, v5
    s_cbranch_vccz PD_51
    s_sub_u32 s78, s78, 1
    s_cbranch_scc0 P_52
PD_51:
    s_nop 0
    v_pk_add_f32 v[24:25], v[24:25], v[26:27]
    v_pk_add_f32 v[28:29], v[28:29], v[30:31]
    v_pk_add_f32 v[24:25], v[24:25], v[28:29]
    s_cmp_lg_u32 s58, 0
    s_cbranch_scc1 B_up
    v_cvt_pk_bf16_f32 v24, 0, v24
    v_cvt_pk_bf16_f32 v25, 0, v25
    v_mul_f32 v26, v24, v24
    v_mul_f32 v27, v25, v25
    v_mul_f32 v26, 0xbdd2d3e8, v26
    v_mul_f32 v27, 0xbdd2d3e8, v27
    v_add_f32 v26, 0xc0135761, v26
    v_add_f32 v27, 0xc0135761, v27
    v_mul_f32 v26, v26, v24
    v_mul_f32 v27, v27, v25
    v_exp_f32 v26, v26
    v_exp_f32 v27, v27
    v_add_f32 v26, 1.0, v26
    v_add_f32 v27, 1.0, v27
    v_rcp_f32 v26, v26
    v_rcp_f32 v27, v27
    v_mul_f32 v24, v24, v26
    v_mul_f32 v25, v25, v27
B_up:
    s_nop 0
    v_mov_b32_dpp v26, v24 quad_perm:[1,0,3,2] row_mask:0xf bank_mask:0xf
    v_mov_b32_dpp v27, v25 quad_perm:[1,0,3,2] row_mask:0xf bank_mask:0xf
    v_cvt_pk_bf16_f32 v24, v24, v26
    v_cvt_pk_bf16_f32 v25, v25, v27
    s_and_b64 exec, s[92:93], s[94:95]
    s_cmp_eq_u32 s79, 1
    s_cbranch_scc0 SLOW_53
    buffer_store_dword v24, v8, s[32:35], s57 offen
    buffer_store_dword v25, v8, s[32:35], s57 offen offset:128
BACK_54:
    s_nop 0
TB_end:
    s_cmp_lg_u32 s92, 0
    s_cbranch_scc1 L_fin
    s_mov_b64 s[92:93], -1
    s_mov_b64 exec, -1
    s_branch TB_back
L_chainA:
    s_sub_u32 s90, s73, 16
    v_bfe_u32 v10, v1, 3, 2
    v_lshlrev_b32 v10, 17, v10
    v_bfe_u32 v4, v1, 5, 1
    v_lshl_add_u32 v10, v4, 10, v10
    v_add_u32 v10, v10, v11
    v_xor_b32 v11, 64, v10
    s_lshl_b32 s81, s72, 5
    s_lshr_b32 s56, s90, 3
    s_lshl_b32 s82, s56, 2
    s_add_u32 s81, s81, s82
    s_add_u32 s81, s81, s76
    s_lshl_b32 s81, s81, 14
    s_and_b32 s57, s90, 7
    s_lshl_b32 s82, s57, 7
    s_add_u32 s81, s81, s82
    s_lshl_b32 s82, s76, 13
    s_waitcnt lgkmcnt(0)
    s_mov_b32 s40, s12
    s_mov_b32 s41, s13
    s_mov_b32 s42, 0x400000
    s_mov_b32 s43, 0x20000
    s_add_u32 s83, s81, 0x0
    s_add_u32 m0, s82, 0x5000
    s_nop 0
    buffer_load_dwordx4 v10, s[40:43], s83 offen nt lds
    s_add_u32 s83, s81, 0x800
    s_add_u32 m0, s82, 0x5400
    s_nop 0
    buffer_load_dwordx4 v11, s[40:43], s83 offen nt lds
    s_add_u32 s83, s81, 0x1000
    s_add_u32 m0, s82, 0x5800
    s_nop 0
    buffer_load_dwordx4 v10, s[40:43], s83 offen nt lds
    s_add_u32 s83, s81, 0x1800
    s_add_u32 m0, s82, 0x5c00
    s_nop 0
    buffer_load_dwordx4 v11, s[40:43], s83 offen nt lds
    s_add_u32 s83, s81, 0x2000
    s_add_u32 m0, s82, 0x6000
    s_nop 0
    buffer_load_dwordx4 v10, s[40:43], s83 offen nt lds
    s_add_u32 s83, s81, 0x2800
    s_add_u32 m0, s82, 0x6400
    s_nop 0
    buffer_load_dwordx4 v11, s[40:43], s83 offen nt lds
    s_barrier
    s_mov_b32 s44, s20
    s_mov_b32 s45, s21
    s_mov_b32 s46, 0x1c0000
    s_mov_b32 s47, 0x20000
    s_mov_b32 s32, s30
    s_mov_b32 s33, s31
    s_mov_b32 s34, 0x800000
    s_mov_b32 s35, 0x20000
    s_mov_b32 s48, s4
    s_mov_b32 s49, s5
    s_mov_b32 s50, 0x1000
    s_mov_b32 s51, 0x20000
    s_mov_b32 s52, s26
    s_mov_b32 s53, s27
    s_mov_b32 s54, 0x1000
    s_mov_b32 s55, 0x20000
    s_waitcnt vmcnt(5)
    s_add_u32 s83, s81, 0x3000
    s_add_u32 m0, s82, 0x6800
    s_nop 0
    buffer_load_dwordx4 v10, s[40:43], s83 offen nt lds
    s_waitcnt vmcnt(5)
    s_add_u32 s83, s81, 0x3800
    s_add_u32 m0, s82, 0x6c00
    s_nop 0
    buffer_load_dwordx4 v11, s[40:43], s83 offen nt lds
    v_bfe_u32 v10, v1, 4, 2
    v_lshlrev_b32 v10, 13, v10
    v_bfe_u32 v4, v1, 2, 2
    v_lshl_add_u32 v10, v4, 10, v10
    v_bfe_u32 v4, v1, 0, 2
    v_lshl_add_u32 v10, v4, 4, v10
    v_bfe_u32 v5, v1, 4, 1
    v_lshlrev_b32 v5, 5, v5
    v_xor_b32 v10, v10, v5
    s_mul_i32 s81, s72, 229376
    s_lshl_b32 s83, s90, 6
    s_add_u32 s81, s81, s83
    s_lshr_b32 s83, s76, 1
    s_lshl_b32 s83, s83, 15
    s_add_u32 s81, s81, s83
    s_and_b32 s80, s76, 1
    s_lshl_b32 s83, s80, 12
    s_add_u32 s81, s81, s83
    s_lshl_b32 s82, s76, 10
    s_waitcnt vmcnt(4)
    s_add_u32 m0, s82, 0xd000
    s_nop 0
    buffer_load_dwordx4 v10, s[44:47], s81 offen nt lds
    s_add_u32 s81, s81, 65536
    s_waitcnt vmcnt(3)
    s_add_u32 m0, s82, 0xe000
    s_nop 0
    buffer_load_dwordx4 v10, s[44:47], s81 offen nt lds
    s_add_u32 s81, s81, 65536
    s_waitcnt vmcnt(2)
    s_add_u32 m0, s82, 0xf000
    s_nop 0
    buffer_load_dwordx4 v10, s[44:47], s81 offen nt lds
    s_add_u32 s81, s81, 65536
    s_cmp_ge_u32 s76, 2
    s_cbranch_scc1 A_dn3
    s_waitcnt vmcnt(1)
    s_add_u32 m0, s82, 0x10000
    s_nop 0
    buffer_load_dwordx4 v10, s[44:47], s81 offen nt lds
A_dn3:
    s_lshl_b32 s91, s76, 2
    s_add_u32 s91, s91, 0x2c60
    v_mov_b32 v12, s91
    v_mov_b32 v13, 1
    ds_write_b32 v12, v13
    s_lshl_b32 s84, s90, 1
    s_add_u32 s84, s84, s80
    s_lshl_b32 s85, s84, 7
    s_lshl_b32 s86, s84, 8
    s_lshl_b32 s87, s84, 5
    s_add_u32 s60, s86, 0x18000
    s_add_u32 s61, s86, 0x58000
    s_add_u32 s62, s86, 0x1c000
    s_add_u32 s63, s86, 0x5c000
    s_and_b32 s83, s86, 0x700
    s_lshr_b32 s86, s84, 4
    s_lshl_b32 s86, s86, 11
    s_add_u32 s86, s86, s83
    s_add_u32 s64, s86, 0x15000
    s_add_u32 s65, s86, 0x55000
    s_add_u32 s66, s77, s85
    s_add_u32 s66, s66, 0x3000
    s_add_u32 s67, s77, s86
    s_add_u32 s67, s67, 0x5000
    s_lshl_b32 s68, s57, 2
    s_add_u32 s68, s68, s76
    s_lshl_b32 s68, s68, 8
    s_lshl_b32 s83, s56, 14
    s_add_u32 s68, s68, s83
    s_add_u32 s68, s68, s77
    s_add_u32 s68, s68, 0x8000
    v_bfe_u32 v160, v1, 2, 4
    v_lshlrev_b32 v160, 4, v160
    v_bfe_u32 v4, v1, 0, 1
    v_lshl_add_u32 v160, v4, 13, v160
    s_lshl_b32 s69, s56, 9
    s_add_u32 s69, s69, s77
    s_add_u32 s69, s69, 0x2000
    s_add_u32 s70, s77, 0x4000
    v_bfe_u32 v131, v1, 2, 2
    v_lshlrev_b32 v131, 10, v131
    v_bfe_u32 v4, v1, 0, 2
    v_lshl_add_u32 v131, v4, 3, v131
    v_bfe_u32 v4, v1, 4, 2
    v_lshl_add_u32 v131, v4, 1, v131
    v_bfe_u32 v132, v1, 0, 4
    v_lshlrev_b32 v132, 3, v132
    v_bfe_u32 v4, v1, 4, 2
    v_lshl_add_u32 v132, v4, 1, v132
    v_bfe_u32 v11, v1, 4, 2
    v_lshlrev_b32 v11, 16, v11
    v_bfe_u32 v4, v1, 0, 4
    v_lshl_add_u32 v11, v4, 4, v11
    v_bfe_u32 v133, v1, 4, 2
    v_lshlrev_b32 v133, 4, v133
    v_bfe_u32 v4, v1, 0, 3
    v_lshl_add_u32 v133, v4, 1, v133
    v_bfe_u32 v4, v1, 2, 2
    v_min_u32 v4, 2, v4
    v_bfe_u32 v134, v1, 5, 1
    v_lshlrev_b32 v134, 7, v134
    v_bfe_u32 v5, v1, 0, 2
    v_lshl_add_u32 v134, v5, 5, v134
    v_bfe_u32 v5, v1, 4, 1
    v_lshl_add_u32 v134, v5, 4, v134
    v_lshl_add_u32 v134, v4, 8, v134
    s_waitcnt vmcnt(0)
    s_lshl_b32 s91, s76, 2
    s_add_u32 s91, s91, 0x2c50
    v_mov_b32 v4, s91
    v_mov_b32 v5, 1
    ds_write_b32 v4, v5
    v_mov_b32 v4, 0x2c50
    s_mov_b32 s78, 400000
P_57:
    ds_read_b128 v[12:15], v4
    s_waitcnt lgkmcnt(0)
    v_max3_u32 v16, v12, v13, v14
    v_max_u32 v16, v16, v15
    v_cmp_eq_u32 vcc, -1, v16
    s_cbranch_vccz PD_56
    s_sub_u32 s78, s78, 1
    s_cbranch_scc0 P_57
PD_56:
    s_nop 0
    s_lshl_b32 s81, s76, 5
    v_xor_b32 v7, s81, v7
    ds_read_b64_tr_b16 v[64:65], v7 offset:20480
    ds_read_b64_tr_b16 v[66:67], v7 offset:20992
    ds_read_b64_tr_b16 v[68:69], v7 offset:24576
    ds_read_b64_tr_b16 v[70:71], v7 offset:25088
    ds_read_b64_tr_b16 v[72:73], v7 offset:28672
    ds_read_b64_tr_b16 v[74:75], v7 offset:29184
    ds_read_b64_tr_b16 v[76:77], v7 offset:32768
    ds_read_b64_tr_b16 v[78:79], v7 offset:33280
    s_waitcnt lgkmcnt(0)
    ds_read_b64_tr_b16 v[80:81], v7 offset:36864
    ds_read_b64_tr_b16 v[82:83], v7 offset:37376
    ds_read_b64_tr_b16 v[84:85], v7 offset:40960
    ds_read_b64_tr_b16 v[86:87], v7 offset:41472
    ds_read_b64_tr_b16 v[88:89], v7 offset:45056
    ds_read_b64_tr_b16 v[90:91], v7 offset:45568
    ds_read_b64_tr_b16 v[92:93], v7 offset:49152
    ds_read_b64_tr_b16 v[94:95], v7 offset:49664
    s_waitcnt lgkmcnt(0)
    v_bfe_u32 v7, v1, 2, 4
    v_lshlrev_b32 v7, 6, v7
    v_bfe_u32 v4, v1, 4, 1
    v_lshl_add_u32 v7, v4, 5, v7
    v_bfe_u32 v4, v1, 0, 2
    v_lshl_add_u32 v7, v4, 3, v7
    s_lshl_b32 s81, s80, 5
    v_xor_b32 v7, s81, v7
    v_add_u32 v7, 0xd000, v7
    ds_read_b64_tr_b16 v[96:97], v7 offset:0
    ds_read_b64_tr_b16 v[98:99], v7 offset:1024
    ds_read_b64_tr_b16 v[100:101], v7 offset:2048
    ds_read_b64_tr_b16 v[102:103], v7 offset:3072
    ds_read_b64_tr_b16 v[104:105], v7 offset:4096
    ds_read_b64_tr_b16 v[106:107], v7 offset:5120
    ds_read_b64_tr_b16 v[108:109], v7 offset:6144
    ds_read_b64_tr_b16 v[110:111], v7 offset:7168
    ds_read_b64_tr_b16 v[112:113], v7 offset:8192
    ds_read_b64_tr_b16 v[114:115], v7 offset:9216
    ds_read_b64_tr_b16 v[116:117], v7 offset:10240
    ds_read_b64_tr_b16 v[118:119], v7 offset:11264
    ds_read_b64_tr_b16 v[120:121], v7 offset:12288
    ds_read_b64_tr_b16 v[122:123], v7 offset:13312
    s_waitcnt lgkmcnt(0)
    s_lshl_b32 s91, s76, 2
    s_add_u32 s91, s91, 0x2c40
    v_mov_b32 v12, s91
    v_mov_b32 v13, 1
    ds_write_b32 v12, v13
    s_cmp_lg_u32 s76, 3
    s_cbranch_scc1 A_noq
    v_mov_b32 v4, 0x2c70
    s_mov_b32 s78, 400000
P_60:
    ds_read_b32 v12, v4
    s_waitcnt lgkmcnt(0)
    v_cmp_eq_u32 vcc, -1, v12
    s_cbranch_vccz PD_59
    s_sub_u32 s78, s78, 1
    s_cbranch_scc0 P_60
PD_59:
    s_nop 0
    v_lshlrev_b32 v4, 4, v1
    s_lshl_b32 s80, s74, 10
    s_add_u32 s80, s80, s77
    s_add_u32 s81, s80, 0x6000
    s_mov_b32 s78, 200
P_63:
    buffer_load_dwordx4 v[16:19], v4, s[32:35], s81 offen sc1
    s_waitcnt vmcnt(0)
    v_max3_u32 v5, v16, v17, v18
    v_max_u32 v5, v5, v19
    v_cmp_eq_u32 vcc, -1, v5
    s_cbranch_vccz PD_62
    s_mov_b64 exec, vcc
    s_sub_u32 s78, s78, 1
    s_cbranch_scc0 P_63
    s_mov_b32 s78, 40000
P_64:
    buffer_load_dwordx4 v[16:19], v4, s[32:35], s80 offen offset:0 sc1
    s_waitcnt vmcnt(0)
    v_max3_u32 v5, v16, v17, v18
    v_max_u32 v5, v5, v19
    v_cmp_eq_u32 vcc, -1, v5
    s_cbranch_vccz PD_62
    s_mov_b64 exec, vcc
    s_sub_u32 s78, s78, 1
    s_cbranch_scc0 P_64
PD_62:
    s_mov_b64 exec, s[92:93]
    ds_write_b128 v4, v[16:19] offset:6144
    s_waitcnt vmcnt(0)
    s_branch A_now
A_noq:
    v_mov_b32 v4, 0x2c70
    s_mov_b32 s78, 400000
P_67:
    ds_read_b32 v12, v4
    s_waitcnt lgkmcnt(0)
    v_cmp_eq_u32 vcc, -1, v12
    s_cbranch_vccz PD_66
    s_sub_u32 s78, s78, 1
    s_cbranch_scc0 P_67
PD_66:
    s_nop 0
    s_lshl_b32 s91, s76, 2
    s_add_u32 s91, s91, 0x2c00
    v_mov_b32 v4, s91
    s_mov_b32 s78, 400000
P_70:
    ds_read_b32 v12, v4
    s_waitcnt lgkmcnt(0)
    v_cmp_eq_u32 vcc, -1, v12
    s_cbranch_vccz PD_69
    s_sub_u32 s78, s78, 1
    s_cbranch_scc0 P_70
PD_69:
    s_nop 0
    s_cmp_lg_u32 s76, 2
    s_cbranch_scc1 A_g
    s_getreg_b32 s81, hwreg(HW_REG_XCC_ID)
    s_and_b32 s81, s81, 0xf
    s_add_u32 s80, s77, 0x1400
    v_bfe_u32 v4, v1, 0, 5
    v_lshlrev_b32 v4, 2, v4
    s_mov_b32 s78, 40000
P_73:
    buffer_load_dword v20, v4, s[32:35], s80 offen sc1
    s_waitcnt vmcnt(0)
    v_cmp_eq_u32 vcc, -1, v20
    s_cbranch_vccz PD_72
    s_mov_b64 exec, vcc
    s_sub_u32 s78, s78, 1
    s_cbranch_scc0 P_73
PD_72:
    s_mov_b64 exec, s[92:93]
    v_cmp_ne_u32 vcc, s81, v20
    s_cmp_eq_u32 vcc_lo, 0
    s_cselect_b32 s79, 1, 0
    v_mov_b32 v20, s79
    v_mov_b32 v4, 0x2c74
    ds_write_b32 v4, v20
    s_branch A_now
A_g:
    buffer_load_ushort v128, v131, s[48:51], s87 offen
    s_add_u32 s80, s85, 16384
    s_add_u32 s81, s85, 28672
    s_mov_b32 s78, 40000
P_76:
    buffer_load_ushort v129, v132, s[32:35], s80 offen sc1
    buffer_load_ushort v130, v132, s[32:35], s81 offen sc1
    s_waitcnt vmcnt(0)
    v_max_u32 v5, v129, v130
    v_cmp_eq_u32 vcc, 0xffff, v5
    s_cbranch_vccz PD_75
    s_mov_b64 exec, vcc
    s_sub_u32 s78, s78, 1
    s_cbranch_scc0 P_76
PD_75:
    s_mov_b64 exec, s[92:93]
    v_lshlrev_b32 v128, 16, v128
    v_lshlrev_b32 v129, 16, v129
    v_lshlrev_b32 v130, 16, v130
A_now:
    v_mov_b32 v4, 0x2c74
    s_mov_b32 s78, 400000
P_79:
    ds_read_b32 v12, v4
    s_waitcnt lgkmcnt(0)
    v_cmp_eq_u32 vcc, -1, v12
    s_cbranch_vccz PD_78
    s_sub_u32 s78, s78, 1
    s_cbranch_scc0 P_79
PD_78:
    s_nop 0
    v_readfirstlane_b32 s79, v12
    v_mov_b32 v4, 0x2c70
    s_mov_b32 s78, 400000
P_82:
    ds_read_b32 v12, v4
    s_waitcnt lgkmcnt(0)
    v_cmp_eq_u32 vcc, -1, v12
    s_cbranch_vccz PD_81
    s_sub_u32 s78, s78, 1
    s_cbranch_scc0 P_82
PD_81:
    s_nop 0
    v_readfirstlane_b32 s71, v12
    s_cmp_gt_u32 s71, 64
    s_cselect_b32 s71, 1, 0
    s_lshr_b32 s83, s72, 2
    s_xor_b32 s83, s83, s71
    s_lshl_b32 s83, s83, 13
    s_add_u32 s60, s60, s83
    s_add_u32 s61, s61, s83
    s_add_u32 s62, s62, s83
    s_add_u32 s63, s63, s83
    s_add_u32 s64, s64, s83
    s_add_u32 s65, s65, s83
    s_lshr_b32 s83, s57, 2
    s_xor_b32 s83, s83, s71
    s_lshl_b32 s83, s83, 13
    s_add_u32 s67, s67, s83
    v_bfe_u32 v10, v1, 3, 3
    v_lshlrev_b32 v10, 11, v10
    v_bfe_u32 v4, v1, 0, 3
    v_lshl_add_u32 v10, v4, 4, v10
    v_bfe_u32 v14, v1, 3, 3
    v_lshlrev_b32 v14, 4, v14
    s_lshl_b32 s80, s72, 2
    s_add_u32 s80, s80, s74
    s_lshl_b32 s80, s80, 14
    s_sub_u32 s89, s75, 4
    s_lshl_b32 s81, s89, 9
    s_add_u32 s80, s80, s81
    s_lshl_b32 s81, s76, 7
    s_add_u32 s80, s80, s81
    s_add_u32 s80, s80, 0x100000
    s_lshl_b32 s59, s72, 5
    s_lshl_b32 s91, s74, 3
    s_add_u32 s59, s59, s91
    s_add_u32 s59, s59, s75
    s_lshl_b32 s59, s59, 2
    s_add_u32 s59, s59, s76
    s_lshl_b32 s59, s59, 9
    s_add_u32 s59, s59, 0x100000
    s_lshl_b32 s91, s76, 9
    v_add_u32 v13, s91, v6
    s_lshl_b32 s88, s74, 10
    s_lshl_b32 s89, s89, 8
    s_add_u32 s88, s88, s89
    s_lshl_b32 s89, s76, 6
    s_add_u32 s88, s88, s89
    s_add_u32 s88, s88, s77
    s_add_u32 s88, s88, 0x2000
    s_lshl_b32 s80, s72, 2
    s_add_u32 s80, s80, s76
    s_lshl_b32 s80, s80, 4
    s_add_u32 s80, s80, s56
    s_lshl_b32 s80, s80, 10
    s_add_u32 s80, s80, 0x100000
    s_add_u32 s81, s80, 0x1000
    s_add_u32 s88, s80, 0x2000
    s_add_u32 s89, s80, 0x3000
    v_lshlrev_b32 v10, 4, v1
    s_lshl_b32 s83, s76, 7
    v_mov_b32 v14, s83
    s_mul_i32 s83, s76, 528
    v_add_u32 v133, s83, v6
    v_bfe_u32 v2, v1, 0, 2
    v_lshlrev_b32 v2, 9, v2
    v_bfe_u32 v4, v1, 0, 2
    v_lshl_add_u32 v2, v4, 4, v2
    v_bfe_u32 v4, v1, 2, 2
    v_lshl_add_u32 v2, v4, 6, v2
    v_bfe_u32 v4, v1, 4, 2
    v_lshl_add_u32 v2, v4, 4, v2
    s_mov_b32 s94, 0x550055
    s_mov_b32 s95, 0x550055
    s_mov_b32 s96, 0x11111111
    s_mov_b32 s97, 0x11111111
    s_mov_b32 s98, 0xffff
    s_mov_b32 s99, 0xffff
    s_mov_b64 s[92:93], 0
    s_mov_b64 exec, 0
    s_branch TA_body
TA_real:
    v_bfe_u32 v4, v1, 0, 1
    v_lshlrev_b32 v4, 3, v4
    s_mov_b32 s78, 400000
P_85:
    ds_read_b64 v[24:25], v4 offset:11520
    ds_read_b64 v[26:27], v4 offset:11536
    ds_read_b64 v[28:29], v4 offset:11552
    ds_read_b64 v[30:31], v4 offset:11568
    s_waitcnt lgkmcnt(0)
    v_max3_u32 v5, v24, v25, v26
    v_max3_u32 v5, v5, v27, v28
    v_max3_u32 v5, v5, v29, v30
    v_max_u32 v5, v5, v31
    v_cmp_eq_u32 vcc, -1, v5
    s_cbranch_vccz PD_84
    s_sub_u32 s78, s78, 1
    s_cbranch_scc0 P_85
PD_84:
    s_nop 0
TA_body:
    s_mov_b64 s[36:37], s[92:93]
    s_mov_b64 s[38:39], s[92:93]
    s_mov_b64 s[40:41], s[92:93]
    s_mov_b64 s[42:43], s[92:93]
    s_mov_b64 s[44:45], s[92:93]
    s_mov_b64 s[46:47], s[92:93]
    s_mov_b64 s[48:49], s[92:93]
    s_mov_b64 s[50:51], s[92:93]
    s_mov_b32 s78, 400000
P_88:
    ds_read_b64 v[16:17], v13 offset:12288
    ds_read_b64 v[18:19], v13 offset:14336
    ds_read_b64 v[20:21], v13 offset:16384
    ds_read_b64 v[22:23], v13 offset:18432
    s_waitcnt lgkmcnt(0)
    v_max3_u32 v5, v16, v17, v18
    v_max3_u32 v5, v5, v19, v20
    v_max3_u32 v5, v5, v21, v22
    v_max_u32 v5, v5, v23
    v_cmp_eq_u32 vcc, -1, v5
    s_cbranch_vccz PD_87
    s_sub_u32 s78, s78, 1
    s_cbranch_scc0 P_88
PD_87:
    s_nop 0
    v_pk_mul_f32 v[16:17], v[16:17], v[24:25]
    v_pk_mul_f32 v[20:21], v[20:21], v[28:29]
    v_pk_fma_f32 v[16:17], v[18:19], v[26:27], v[16:17]
    v_pk_fma_f32 v[20:21], v[22:23], v[30:31], v[20:21]
    v_pk_add_f32 v[16:17], v[16:17], v[20:21]
    s_cmp_eq_u32 s79, 1
    s_cbranch_scc0 SLOW_89
    buffer_store_dwordx2 v[16:17], v6, s[32:35], s59 offen
BACK_90:
    s_nop 0
    s_mov_b32 s78, 400000
P_93:
    ds_read_b128 v[32:35], v14 offset:2560
    ds_read_b128 v[36:39], v14 offset:2576
    ds_read_b128 v[40:43], v14 offset:2592
    ds_read_b128 v[44:47], v14 offset:2608
    ds_read_b128 v[48:51], v14 offset:2624
    ds_read_b128 v[52:55], v14 offset:2640
    ds_read_b128 v[56:59], v14 offset:2656
    ds_read_b128 v[60:63], v14 offset:2672
    s_waitcnt lgkmcnt(0)
    v_max_u32 v5, v32, v63
    v_cmp_eq_u32 vcc, -1, v5
    s_cbranch_vccz PD_92
    s_sub_u32 s78, s78, 1
    s_cbranch_scc0 P_93
PD_92:
    s_nop 0
    s_mov_b32 s78, 40000
OPL_94:
    s_mov_b64 exec, s[36:37]
    buffer_load_dwordx4 v[16:19], v10, s[32:35], s80 offen offset:0 sc1
    s_mov_b64 exec, s[38:39]
    buffer_load_dwordx4 v[20:23], v10, s[32:35], s80 offen offset:2048 sc1
    s_mov_b64 exec, s[40:41]
    buffer_load_dwordx4 v[24:27], v10, s[32:35], s81 offen offset:0 sc1
    s_mov_b64 exec, s[42:43]
    buffer_load_dwordx4 v[28:31], v10, s[32:35], s81 offen offset:2048 sc1
    s_mov_b64 exec, s[44:45]
    buffer_load_dwordx4 v[136:139], v10, s[32:35], s88 offen offset:0 sc1
    s_mov_b64 exec, s[46:47]
    buffer_load_dwordx4 v[140:143], v10, s[32:35], s88 offen offset:2048 sc1
    s_mov_b64 exec, s[48:49]
    buffer_load_dwordx4 v[144:147], v10, s[32:35], s89 offen offset:0 sc1
    s_mov_b64 exec, s[50:51]
    buffer_load_dwordx4 v[148:151], v10, s[32:35], s89 offen offset:2048 sc1
    s_mov_b64 exec, s[92:93]
    s_sub_u32 s78, s78, 1
    s_cselect_b32 s95, 0, -1
    s_waitcnt vmcnt(0)
    v_cmp_u_f32 s[36:37], v16, v18
    v_cmp_u_f32 s[38:39], v20, v22
    v_cmp_u_f32 s[40:41], v24, v26
    v_cmp_u_f32 s[42:43], v28, v30
    v_cmp_u_f32 s[44:45], v136, v138
    v_cmp_u_f32 s[46:47], v140, v142
    v_cmp_u_f32 s[48:49], v144, v146
    v_cmp_u_f32 s[50:51], v148, v150
    s_mov_b32 s94, 0
    s_cmp_lg_u64 s[36:37], 0
    s_addc_u32 s94, s94, s94
    s_cmp_lg_u64 s[38:39], 0
    s_addc_u32 s94, s94, s94
    s_cmp_lg_u64 s[40:41], 0
    s_addc_u32 s94, s94, s94
    s_cmp_lg_u64 s[42:43], 0
    s_addc_u32 s94, s94, s94
    s_cmp_lg_u64 s[44:45], 0
    s_addc_u32 s94, s94, s94
    s_cmp_lg_u64 s[46:47], 0
    s_addc_u32 s94, s94, s94
    s_cmp_lg_u64 s[48:49], 0
    s_addc_u32 s94, s94, s94
    s_cmp_lg_u64 s[50:51], 0
    s_addc_u32 s94, s94, s94
    s_and_b32 s94, s94, s95
    s_cbranch_scc0 OP_dn
    s_bcnt1_i32_b32 s83, s94
    s_cmp_gt_u32 s83, 1
    s_cbranch_scc1 OPL_94
    s_bitcmp1_b32 s94, 6
    s_cbranch_scc1 OP_t1
    s_bitcmp1_b32 s94, 5
    s_cbranch_scc1 OP_t2
    s_bitcmp1_b32 s94, 4
    s_cbranch_scc1 OP_t3
    s_bitcmp1_b32 s94, 3
    s_cbranch_scc1 OP_t4
    s_bitcmp1_b32 s94, 2
    s_cbranch_scc1 OP_t5
    s_bitcmp1_b32 s94, 1
    s_cbranch_scc1 OP_t6
    s_bitcmp1_b32 s94, 0
    s_cbranch_scc1 OP_t7
OP_t0:
    buffer_load_dwordx4 v[16:19], v10, s[32:35], s80 offen offset:0 sc1
    s_waitcnt vmcnt(0)
    v_cmp_u_f32 vcc, v16, v18
    s_cbranch_vccz OP_dn
    s_mov_b64 exec, vcc
    s_sub_u32 s78, s78, 1
    s_cbranch_scc0 OP_t0
    s_branch OP_dn
OP_t1:
    buffer_load_dwordx4 v[20:23], v10, s[32:35], s80 offen offset:2048 sc1
    s_waitcnt vmcnt(0)
    v_cmp_u_f32 vcc, v20, v22
    s_cbranch_vccz OP_dn
    s_mov_b64 exec, vcc
    s_sub_u32 s78, s78, 1
    s_cbranch_scc0 OP_t1
    s_branch OP_dn
OP_t2:
    buffer_load_dwordx4 v[24:27], v10, s[32:35], s81 offen offset:0 sc1
    s_waitcnt vmcnt(0)
    v_cmp_u_f32 vcc, v24, v26
    s_cbranch_vccz OP_dn
    s_mov_b64 exec, vcc
    s_sub_u32 s78, s78, 1
    s_cbranch_scc0 OP_t2
    s_branch OP_dn
OP_t3:
    buffer_load_dwordx4 v[28:31], v10, s[32:35], s81 offen offset:2048 sc1
    s_waitcnt vmcnt(0)
    v_cmp_u_f32 vcc, v28, v30
    s_cbranch_vccz OP_dn
    s_mov_b64 exec, vcc
    s_sub_u32 s78, s78, 1
    s_cbranch_scc0 OP_t3
    s_branch OP_dn
OP_t4:
    buffer_load_dwordx4 v[136:139], v10, s[32:35], s88 offen offset:0 sc1
    s_waitcnt vmcnt(0)
    v_cmp_u_f32 vcc, v136, v138
    s_cbranch_vccz OP_dn
    s_mov_b64 exec, vcc
    s_sub_u32 s78, s78, 1
    s_cbranch_scc0 OP_t4
    s_branch OP_dn
OP_t5:
    buffer_load_dwordx4 v[140:143], v10, s[32:35], s88 offen offset:2048 sc1
    s_waitcnt vmcnt(0)
    v_cmp_u_f32 vcc, v140, v142
    s_cbranch_vccz OP_dn
    s_mov_b64 exec, vcc
    s_sub_u32 s78, s78, 1
    s_cbranch_scc0 OP_t5
    s_branch OP_dn
OP_t6:
    buffer_load_dwordx4 v[144:147], v10, s[32:35], s89 offen offset:0 sc1
    s_waitcnt vmcnt(0)
    v_cmp_u_f32 vcc, v144, v146
    s_cbranch_vccz OP_dn
    s_mov_b64 exec, vcc
    s_sub_u32 s78, s78, 1
    s_cbranch_scc0 OP_t6
    s_branch OP_dn
OP_t7:
    buffer_load_dwordx4 v[148:151], v10, s[32:35], s89 offen offset:2048 sc1
    s_waitcnt vmcnt(0)
    v_cmp_u_f32 vcc, v148, v150
    s_cbranch_vccz OP_dn
    s_mov_b64 exec, vcc
    s_sub_u32 s78, s78, 1
    s_cbranch_scc0 OP_t7
OP_dn:
    s_mov_b64 exec, s[92:93]
    v_pk_mul_f32 v[152:153], v[16:17], v[32:33]
    v_pk_mul_f32 v[154:155], v[18:19], v[34:35]
    v_pk_fma_f32 v[152:153], v[20:21], v[36:37], v[152:153]
    v_pk_fma_f32 v[154:155], v[22:23], v[38:39], v[154:155]
    v_pk_fma_f32 v[152:153], v[24:25], v[40:41], v[152:153]
    v_pk_fma_f32 v[154:155], v[26:27], v[42:43], v[154:155]
    v_pk_fma_f32 v[152:153], v[28:29], v[44:45], v[152:153]
    v_pk_fma_f32 v[154:155], v[30:31], v[46:47], v[154:155]
    v_pk_fma_f32 v[152:153], v[136:137], v[48:49], v[152:153]
    v_pk_fma_f32 v[154:155], v[138:139], v[50:51], v[154:155]
    v_pk_fma_f32 v[152:153], v[140:141], v[52:53], v[152:153]
    v_pk_fma_f32 v[154:155], v[142:143], v[54:55], v[154:155]
    v_pk_fma_f32 v[152:153], v[144:145], v[56:57], v[152:153]
    v_pk_fma_f32 v[154:155], v[146:147], v[58:59], v[154:155]
    v_pk_fma_f32 v[152:153], v[148:149], v[60:61], v[152:153]
    v_pk_fma_f32 v[154:155], v[150:151], v[62:63], v[154:155]
    v_cvt_pk_bf16_f32 v152, v152, v153
    v_cvt_pk_bf16_f32 v153, v154, v155
    ds_write_b64 v133, v[152:153] offset:0
    s_mov_b32 s78, 400000
P_97:
    ds_read_b128 v[16:19], v2 offset:0
    ds_read_b128 v[20:23], v2 offset:256
    s_waitcnt lgkmcnt(0)
    v_max3_u32 v5, v16, v18, v20
    v_max_u32 v5, v5, v22
    v_cmp_eq_u32 vcc, -1, v5
    s_cbranch_vccz PD_96
    s_sub_u32 s78, s78, 1
    s_cbranch_scc0 P_97
PD_96:
    s_nop 0
    v_mfma_f32_16x16x32_bf16 v[32:35], v[16:19], v[64:67], 0
    v_mfma_f32_16x16x32_bf16 v[36:39], v[16:19], v[68:71], 0
    v_mfma_f32_16x16x32_bf16 v[40:43], v[16:19], v[72:75], 0
    v_mfma_f32_16x16x32_bf16 v[44:47], v[16:19], v[76:79], 0
    v_mfma_f32_16x16x32_bf16 v[32:35], v[20:23], v[80:83], v[32:35]
    v_mfma_f32_16x16x32_bf16 v[36:39], v[20:23], v[84:87], v[36:39]
    v_mfma_f32_16x16x32_bf16 v[40:43], v[20:23], v[88:91], v[40:43]
    v_mfma_f32_16x16x32_bf16 v[44:47], v[20:23], v[92:95], v[44:47]
    s_nop 4
    v_permlane16_swap_b32 v32, v33
    v_permlane16_swap_b32 v36, v37
    v_permlane16_swap_b32 v40, v41
    v_permlane16_swap_b32 v44, v45
    v_permlane16_swap_b32 v34, v35
    v_permlane16_swap_b32 v38, v39
    v_permlane16_swap_b32 v42, v43
    v_permlane16_swap_b32 v46, v47
    v_add_f32 v32, v32, v37
    v_add_f32 v34, v34, v39
    v_add_f32 v40, v40, v45
    v_add_f32 v42, v42, v47
    v_permlane32_swap_b32 v32, v34
    s_nop 0
    v_permlane32_swap_b32 v40, v42
    v_add_f32 v52, v32, v42
    s_nop 1
    v_mov_b32_dpp v48, v52 quad_perm:[0,0,0,0] row_mask:0xf bank_mask:0xf
    v_mov_b32_dpp v49, v52 quad_perm:[1,1,1,1] row_mask:0xf bank_mask:0xf
    v_mov_b32_dpp v50, v52 quad_perm:[2,2,2,2] row_mask:0xf bank_mask:0xf
    v_mov_b32_dpp v51, v52 quad_perm:[3,3,3,3] row_mask:0xf bank_mask:0xf
    s_and_b32 exec_lo, s92, 0x33333333
    s_and_b32 exec_hi, s93, 0x33333333
    buffer_store_dwordx4 v[48:51], v160, s[32:35], s68 offen sc1
    s_mov_b64 exec, s[92:93]
    s_cmp_ge_u32 s76, 2
    s_cbranch_scc1 A_down
    buffer_load_dwordx4 v[16:19], v11, s[32:35], s60 offen sc1
    buffer_load_dwordx4 v[20:23], v11, s[32:35], s61 offen sc1
    buffer_load_dwordx4 v[24:27], v11, s[32:35], s62 offen sc1
    buffer_load_dwordx4 v[28:31], v11, s[32:35], s63 offen sc1
    s_mov_b32 s78, 5
DL_101:
    s_nop 13
    s_sub_u32 s78, s78, 1
    s_cbranch_scc0 DL_101
    s_mov_b32 s78, 40000
P_100:
    buffer_load_dwordx4 v[16:19], v11, s[32:35], s60 offen sc1
    buffer_load_dwordx4 v[20:23], v11, s[32:35], s61 offen sc1
    buffer_load_dwordx4 v[24:27], v11, s[32:35], s62 offen sc1
    buffer_load_dwordx4 v[28:31], v11, s[32:35], s63 offen sc1
    s_waitcnt vmcnt(4)
    v_max3_u32 v5, v16, v17, v18
    v_max3_u32 v5, v5, v19, v20
    v_max3_u32 v5, v5, v21, v22
    v_max3_u32 v5, v5, v23, v24
    v_max3_u32 v5, v5, v25, v26
    v_max3_u32 v5, v5, v27, v28
    v_max3_u32 v5, v5, v29, v30
    v_max_u32 v5, v5, v31
    v_cmp_eq_u32 vcc, -1, v5
    s_cbranch_vccz PD_99
    s_mov_b64 exec, vcc
    s_sub_u32 s78, s78, 1
    s_cbranch_scc0 P_100
PD_99:
    s_mov_b64 exec, s[92:93]
    v_pk_add_f32 v[32:33], v[16:17], v[20:21]
    v_pk_add_f32 v[34:35], v[18:19], v[22:23]
    v_pk_add_f32 v[36:37], v[24:25], v[28:29]
    v_pk_add_f32 v[38:39], v[26:27], v[30:31]
    v_pk_add_f32 v[32:33], v[32:33], v[36:37]
    v_pk_add_f32 v[34:35], v[34:35], v[38:39]
    s_nop 1
    v_permlane32_swap_b32 v32, v34
    v_permlane32_swap_b32 v33, v35
    v_add_f32 v32, v32, v34
    v_add_f32 v33, v33, v35
    s_nop 1
    v_permlane16_swap_b32 v32, v33
    v_add_f32 v40, v32, v33
    v_cvt_pk_bf16_f32 v40, 0, v40
    v_mul_f32 v40, v40, v129
    v_cvt_pk_bf16_f32 v40, 0, v40
    v_add_f32 v40, v40, v128
    v_mov_b32 v41, v40
    v_cvt_pk_bf16_f32 v135, 0, v40
    s_nop 0
    v_permlane16_swap_b32 v40, v41
    v_cvt_pk_bf16_f32 v40, v40, v41
    s_and_b64 exec, s[92:93], s[98:99]
    s_cmp_eq_u32 s79, 1
    s_cbranch_scc0 SLOW_102
    buffer_store_dword v40, v132, s[32:35], s66 offen
BACK_103:
    s_nop 0
    s_mov_b64 exec, s[92:93]
    s_cmp_lg_u32 s57, s72
    s_cbranch_scc1 TA_end
    buffer_load_dwordx4 v[16:19], v11, s[32:35], s64 offen sc1
    buffer_load_dwordx4 v[20:23], v11, s[32:35], s65 offen sc1
    s_mov_b32 s78, 5
DL_107:
    s_nop 13
    s_sub_u32 s78, s78, 1
    s_cbranch_scc0 DL_107
    s_mov_b32 s78, 40000
P_106:
    buffer_load_dwordx4 v[16:19], v11, s[32:35], s64 offen sc1
    buffer_load_dwordx4 v[20:23], v11, s[32:35], s65 offen sc1
    s_waitcnt vmcnt(2)
    v_max3_u32 v5, v16, v17, v18
    v_max3_u32 v5, v5, v19, v20
    v_max3_u32 v5, v5, v21, v22
    v_max_u32 v5, v5, v23
    v_cmp_eq_u32 vcc, -1, v5
    s_cbranch_vccz PD_105
    s_mov_b64 exec, vcc
    s_sub_u32 s78, s78, 1
    s_cbranch_scc0 P_106
PD_105:
    s_mov_b64 exec, s[92:93]
    v_pk_add_f32 v[32:33], v[16:17], v[20:21]
    v_pk_add_f32 v[34:35], v[18:19], v[22:23]
    s_nop 1
    v_permlane32_swap_b32 v32, v34
    v_permlane32_swap_b32 v33, v35
    v_add_f32 v32, v32, v34
    v_add_f32 v33, v33, v35
    s_nop 1
    v_permlane16_swap_b32 v32, v33
    v_add_f32 v40, v32, v33
    v_cvt_pk_bf16_f32 v40, 0, v40
    v_mul_f32 v40, v40, v130
    v_cvt_pk_bf16_f32 v40, 0, v40
    v_add_f32 v40, v40, v135
    v_cvt_pk_bf16_f32 v40, 0, v40
    buffer_store_short_d16_hi v40, v131, s[52:55], s87 offen
    s_branch TA_end
A_down:
    buffer_load_dwordx4 v[16:19], v3, s[32:35], s70 offen sc1
    buffer_load_dwordx4 v[20:23], v134, s[32:35], s70 offen offset:1024 sc1
    buffer_load_dwordx4 v[24:27], v3, s[32:35], s70 offen offset:2048 sc1
    buffer_load_dwordx4 v[28:31], v134, s[32:35], s70 offen offset:3072 sc1
    s_nop 15
    s_nop 15
    s_nop 15
    s_nop 15
    s_mov_b32 s78, 40000
P_110:
    buffer_load_dwordx4 v[16:19], v3, s[32:35], s70 offen sc1
    buffer_load_dwordx4 v[20:23], v134, s[32:35], s70 offen offset:1024 sc1
    buffer_load_dwordx4 v[24:27], v3, s[32:35], s70 offen offset:2048 sc1
    buffer_load_dwordx4 v[28:31], v134, s[32:35], s70 offen offset:3072 sc1
    s_waitcnt vmcnt(4)
    v_max3_u32 v5, v16, v17, v18
    v_max3_u32 v5, v5, v19, v20
    v_max3_u32 v5, v5, v21, v22
    v_max3_u32 v5, v5, v23, v24
    v_max3_u32 v5, v5, v25, v26
    v_max3_u32 v5, v5, v27, v28
    v_max3_u32 v5, v5, v29, v30
    v_max_u32 v5, v5, v31
    v_cmp_eq_u32 vcc, -1, v5
    s_cbranch_vccz PD_109
    s_mov_b64 exec, vcc
    s_sub_u32 s78, s78, 1
    s_cbranch_scc0 P_110
PD_109:
    s_mov_b64 exec, s[92:93]
    v_lshlrev_b32 v136, 16, v16
    v_and_b32 v137, 0xffff0000, v16
    v_lshlrev_b32 v138, 16, v17
    v_and_b32 v139, 0xffff0000, v17
    v_lshlrev_b32 v140, 16, v18
    v_and_b32 v141, 0xffff0000, v18
    v_lshlrev_b32 v142, 16, v19
    v_and_b32 v143, 0xffff0000, v19
    v_lshlrev_b32 v144, 16, v24
    v_and_b32 v145, 0xffff0000, v24
    v_lshlrev_b32 v146, 16, v25
    v_and_b32 v147, 0xffff0000, v25
    v_lshlrev_b32 v148, 16, v26
    v_and_b32 v149, 0xffff0000, v26
    v_lshlrev_b32 v150, 16, v27
    v_and_b32 v151, 0xffff0000, v27
    v_pk_mul_f32 v[136:137], v[136:137], v[144:145]
    v_pk_mul_f32 v[138:139], v[138:139], v[146:147]
    v_pk_mul_f32 v[140:141], v[140:141], v[148:149]
    v_pk_mul_f32 v[142:143], v[142:143], v[150:151]
    v_cvt_pk_bf16_f32 v152, v136, v137
    v_cvt_pk_bf16_f32 v153, v138, v139
    v_cvt_pk_bf16_f32 v154, v140, v141
    v_cvt_pk_bf16_f32 v155, v142, v143
    s_nop 1
    v_mfma_f32_16x16x32_bf16 v[32:35], v[152:155], v[96:99], 0
    v_mfma_f32_16x16x32_bf16 v[36:39], v[152:155], v[100:103], 0
    v_mfma_f32_16x16x32_bf16 v[40:43], v[152:155], v[104:107], 0
    v_mfma_f32_16x16x32_bf16 v[44:47], v[152:155], v[108:111], 0
    v_lshlrev_b32 v136, 16, v20
    v_and_b32 v137, 0xffff0000, v20
    v_lshlrev_b32 v138, 16, v21
    v_and_b32 v139, 0xffff0000, v21
    v_lshlrev_b32 v140, 16, v22
    v_and_b32 v141, 0xffff0000, v22
    v_lshlrev_b32 v142, 16, v23
    v_and_b32 v143, 0xffff0000, v23
    v_lshlrev_b32 v144, 16, v28
    v_and_b32 v145, 0xffff0000, v28
    v_lshlrev_b32 v146, 16, v29
    v_and_b32 v147, 0xffff0000, v29
    v_lshlrev_b32 v148, 16, v30
    v_and_b32 v149, 0xffff0000, v30
    v_lshlrev_b32 v150, 16, v31
    v_and_b32 v151, 0xffff0000, v31
    v_pk_mul_f32 v[136:137], v[136:137], v[144:145]
    v_pk_mul_f32 v[138:139], v[138:139], v[146:147]
    v_pk_mul_f32 v[140:141], v[140:141], v[148:149]
    v_pk_mul_f32 v[142:143], v[142:143], v[150:151]
    v_cvt_pk_bf16_f32 v156, v136, v137
    v_cvt_pk_bf16_f32 v157, v138, v139
    v_cvt_pk_bf16_f32 v158, v140, v141
    v_cvt_pk_bf16_f32 v159, v142, v143
    s_nop 1
    v_mfma_f32_16x16x32_bf16 v[32:35], v[156:159], v[112:115], v[32:35]
    v_mfma_f32_16x16x32_bf16 v[36:39], v[156:159], v[116:119], v[36:39]
    v_mfma_f32_16x16x32_bf16 v[40:43], v[156:159], v[120:123], v[40:43]
    s_nop 5
    v_permlane16_swap_b32 v32, v33
    v_permlane16_swap_b32 v36, v37
    v_permlane16_swap_b32 v40, v41
    v_permlane16_swap_b32 v44, v45
    v_permlane16_swap_b32 v34, v35
    v_permlane16_swap_b32 v38, v39
    v_permlane16_swap_b32 v42, v43
    v_permlane16_swap_b32 v46, v47
    v_add_f32 v32, v32, v37
    v_add_f32 v34, v34, v39
    v_add_f32 v40, v40, v45
    v_add_f32 v42, v42, v47
    v_permlane32_swap_b32 v32, v34
    s_nop 0
    v_permlane32_swap_b32 v40, v42
    v_add_f32 v48, v32, v42
    s_nop 1
    v_mov_b32_dpp v49, v48 quad_perm:[1,1,1,1] row_mask:0xf bank_mask:0xf
    v_mov_b32_dpp v50, v48 quad_perm:[2,2,2,2] row_mask:0xf bank_mask:0xf
    v_mov_b32_dpp v51, v48 quad_perm:[3,3,3,3] row_mask:0xf bank_mask:0xf
    s_and_b64 exec, s[92:93], s[96:97]
    buffer_store_dwordx4 v[48:51], v9, s[32:35], s67 offen sc1
TA_end:
    s_cmp_lg_u32 s92, 0
    s_cbranch_scc1 L_fin
    s_mov_b64 s[92:93], -1
    s_mov_b64 exec, -1
    s_branch TA_real
L_k:
    v_bfe_u32 v2, v1, 1, 1
    v_lshlrev_b32 v2, 10, v2
    v_bfe_u32 v4, v1, 2, 2
    v_lshl_add_u32 v2, v4, 8, v2
    v_bfe_u32 v4, v1, 0, 1
    v_lshl_add_u32 v2, v4, 6, v2
    v_bfe_u32 v4, v1, 4, 2
    v_lshl_add_u32 v2, v4, 4, v2
    s_lshl_b32 s80, s74, 3
    s_add_u32 s80, s80, s72
    s_lshl_b32 s80, s80, 22
    s_lshl_b32 s81, s75, 17
    s_add_u32 s80, s80, s81
    s_add_u32 s80, s80, 0x300000
    s_mul_i32 s81, s72, 9
    s_mul_i32 s82, s74, 8
    s_add_u32 s81, s81, s82
    s_mul_i32 s82, s75, 5
    s_add_u32 s81, s81, s82
    s_mul_i32 s82, s76, 1
    s_add_u32 s81, s81, s82
    s_waitcnt lgkmcnt(0)
    s_mov_b32 s40, s6
    s_mov_b32 s41, s7
    s_mov_b32 s42, 0x8000000
    s_mov_b32 s43, 0x20000
    s_mov_b32 s32, s30
    s_mov_b32 s33, s31
    s_mov_b32 s34, 0x800000
    s_mov_b32 s35, 0x20000
    s_cmp_ge_u32 s73, 4
    s_cbranch_scc1 K_np
    s_load_dword s84, s[32:33], 0x94000
    s_lshl_b32 s85, s2, 8
    s_lshr_b32 s86, s76, 1
    s_lshl_b32 s86, s86, 7
    s_add_u32 s85, s85, s86
    s_and_b32 s86, s76, 1
    s_lshl_b32 s86, s86, 13
    s_add_u32 s85, s85, s86
    s_add_u32 s56, s32, s85
    s_addc_u32 s57, s33, 0
    s_barrier
    s_waitcnt lgkmcnt(0)
    s_memtime s[58:59]
    s_load_dword s84, s[56:57], 0x90000
    s_waitcnt lgkmcnt(0)
    s_memtime s[60:61]
    s_xor_b32 s56, s56, 0x2000
    s_load_dword s84, s[56:57], 0x98000
    s_waitcnt lgkmcnt(0)
    s_memtime s[62:63]
    s_lshl_b32 s85, s76, 2
    v_mov_b32 v3, s85
    s_waitcnt lgkmcnt(0)
    s_sub_u32 s62, s62, s60
    s_sub_u32 s60, s60, s58
    s_min_u32 s60, s60, 4000
    s_min_u32 s62, s62, 4000
    s_sub_u32 s60, s60, s62
    s_add_u32 s60, s60, 0x10000
    s_and_b32 s60, s60, 0xffffff
    v_mov_b32 v8, s60
    ds_write_b32 v3, v8 offset:11824
    s_branch K_pd
K_np:
    s_barrier
K_pd:
    s_sub_u32 s83, s73, 4
    s_cmp_lt_u32 s83, 8
    s_cbranch_scc0 K_nq
    s_lshl_b32 s91, s76, 2
    s_add_u32 s91, s91, 0x2e00
    v_mov_b32 v3, s91
    s_mov_b32 s78, 400000
P_113:
    ds_read_b32 v8, v3
    s_waitcnt lgkmcnt(0)
    v_cmp_eq_u32 vcc, -1, v8
    s_cbranch_vccz PD_112
    s_sub_u32 s78, s78, 1
    s_cbranch_scc0 P_113
PD_112:
    s_nop 0
    s_setprio 3
    s_cmp_eq_u32 s73, 7
    s_cbranch_scc1 K_vq7
    s_branch K_vq
K_nq:
    s_lshl_b32 s91, s76, 2
    s_add_u32 s91, s91, 0x2c60
    v_mov_b32 v3, s91
    s_mov_b32 s78, 400000
P_116:
    ds_read_b32 v8, v3
    s_waitcnt lgkmcnt(0)
    v_cmp_eq_u32 vcc, -1, v8
    s_cbranch_vccz PD_115
    s_sub_u32 s78, s78, 1
    s_cbranch_scc0 P_116
PD_115:
    s_nop 0
    s_setprio 3
    s_sub_u32 s83, s73, 4
    s_cmp_ge_u32 s83, 8
    s_cbranch_scc0 K_nv0
    s_cmp_lt_u32 s72, 8
    s_cbranch_scc1 K_v0
K_nv0:
    s_cmp_eq_u32 s73, 7
    s_cbranch_scc1 K_v2
    s_and_b32 s83, s2, 0xf9
    s_cmp_eq_u32 s83, 120
    s_cbranch_scc1 K_v2
    s_branch K_v1
K_v0:
    s_add_u32 s82, s81, 0
    s_and_b32 s82, s82, 31
    s_lshl_b32 s82, s82, 12
    s_add_u32 s82, s82, s80
    buffer_load_dwordx4 v[40:43], v2, s[40:43], s82 offen offset:0 nt
    buffer_load_dwordx4 v[44:47], v2, s[40:43], s82 offen offset:128 nt
    buffer_load_dwordx4 v[48:51], v2, s[40:43], s82 offen offset:2048 nt
    buffer_load_dwordx4 v[52:55], v2, s[40:43], s82 offen offset:2176 nt
    s_add_u32 s82, s81, 4
    s_and_b32 s82, s82, 31
    s_lshl_b32 s82, s82, 12
    s_add_u32 s82, s82, s80
    buffer_load_dwordx4 v[56:59], v2, s[40:43], s82 offen offset:0 nt
    buffer_load_dwordx4 v[60:63], v2, s[40:43], s82 offen offset:128 nt
    s_waitcnt vmcnt(5)
    buffer_load_dwordx4 v[64:67], v2, s[40:43], s82 offen offset:2048 nt
    s_waitcnt vmcnt(5)
    buffer_load_dwordx4 v[68:71], v2, s[40:43], s82 offen offset:2176 nt
    s_add_u32 s82, s81, 8
    s_and_b32 s82, s82, 31
    s_lshl_b32 s82, s82, 12
    s_add_u32 s82, s82, s80
    s_waitcnt vmcnt(5)
    buffer_load_dwordx4 v[72:75], v2, s[40:43], s82 offen offset:0 nt
    s_waitcnt vmcnt(5)
    buffer_load_dwordx4 v[76:79], v2, s[40:43], s82 offen offset:128 nt
    s_waitcnt vmcnt(5)
    buffer_load_dwordx4 v[80:83], v2, s[40:43], s82 offen offset:2048 nt
    s_waitcnt vmcnt(5)
    buffer_load_dwordx4 v[84:87], v2, s[40:43], s82 offen offset:2176 nt
    s_add_u32 s82, s81, 12
    s_and_b32 s82, s82, 31
    s_lshl_b32 s82, s82, 12
    s_add_u32 s82, s82, s80
    s_waitcnt vmcnt(5)
    buffer_load_dwordx4 v[88:91], v2, s[40:43], s82 offen offset:0 nt
    s_waitcnt vmcnt(5)
    buffer_load_dwordx4 v[92:95], v2, s[40:43], s82 offen offset:128 nt
    s_waitcnt vmcnt(5)
    buffer_load_dwordx4 v[96:99], v2, s[40:43], s82 offen offset:2048 nt
    s_waitcnt vmcnt(5)
    buffer_load_dwordx4 v[100:103], v2, s[40:43], s82 offen offset:2176 nt
    s_add_u32 s82, s81, 16
    s_and_b32 s82, s82, 31
    s_lshl_b32 s82, s82, 12
    s_add_u32 s82, s82, s80
    s_waitcnt vmcnt(5)
    buffer_load_dwordx4 v[104:107], v2, s[40:43], s82 offen offset:0 nt
    v_mov_b32 v3, 0x2c78
    ds_write_b32 v3, v3
    s_waitcnt vmcnt(5)
    buffer_load_dwordx4 v[108:111], v2, s[40:43], s82 offen offset:128 nt
    s_waitcnt vmcnt(5)
    buffer_load_dwordx4 v[112:115], v2, s[40:43], s82 offen offset:2048 nt
    s_waitcnt vmcnt(5)
    buffer_load_dwordx4 v[116:119], v2, s[40:43], s82 offen offset:2176 nt
    s_add_u32 s82, s81, 20
    s_and_b32 s82, s82, 31
    s_lshl_b32 s82, s82, 12
    s_add_u32 s82, s82, s80
    s_waitcnt vmcnt(5)
    buffer_load_dwordx4 v[120:123], v2, s[40:43], s82 offen offset:0 nt
    s_waitcnt vmcnt(5)
    buffer_load_dwordx4 v[124:127], v2, s[40:43], s82 offen offset:128 nt
    s_waitcnt vmcnt(5)
    buffer_load_dwordx4 v[128:131], v2, s[40:43], s82 offen offset:2048 nt
    s_waitcnt vmcnt(5)
    buffer_load_dwordx4 v[132:135], v2, s[40:43], s82 offen offset:2176 nt
    s_add_u32 s82, s81, 24
    s_and_b32 s82, s82, 31
    s_lshl_b32 s82, s82, 12
    s_add_u32 s82, s82, s80
    s_waitcnt vmcnt(5)
    buffer_load_dwordx4 v[136:139], v2, s[40:43], s82 offen offset:0 nt
    s_waitcnt vmcnt(5)
    buffer_load_dwordx4 v[140:143], v2, s[40:43], s82 offen offset:128 nt
    s_waitcnt vmcnt(5)
    buffer_load_dwordx4 v[144:147], v2, s[40:43], s82 offen offset:2048 nt
    s_waitcnt vmcnt(5)
    buffer_load_dwordx4 v[148:151], v2, s[40:43], s82 offen offset:2176 nt
    s_add_u32 s82, s81, 28
    s_and_b32 s82, s82, 31
    s_lshl_b32 s82, s82, 12
    s_add_u32 s82, s82, s80
    s_waitcnt vmcnt(5)
    buffer_load_dwordx4 v[152:155], v2, s[40:43], s82 offen offset:0 nt
    s_waitcnt vmcnt(5)
    buffer_load_dwordx4 v[156:159], v2, s[40:43], s82 offen offset:128 nt
    s_waitcnt vmcnt(5)
    buffer_load_dwordx4 v[160:163], v2, s[40:43], s82 offen offset:2048 nt
    s_waitcnt vmcnt(5)
    buffer_load_dwordx4 v[164:167], v2, s[40:43], s82 offen offset:2176 nt
    s_branch K_vd
K_v1:
    s_add_u32 s82, s81, 0
    s_and_b32 s82, s82, 31
    s_lshl_b32 s82, s82, 12
    s_add_u32 s82, s82, s80
    buffer_load_dwordx4 v[40:43], v2, s[40:43], s82 offen offset:0 nt
    buffer_load_dwordx4 v[44:47], v2, s[40:43], s82 offen offset:128 nt
    buffer_load_dwordx4 v[48:51], v2, s[40:43], s82 offen offset:2048 nt
    buffer_load_dwordx4 v[52:55], v2, s[40:43], s82 offen offset:2176 nt
    s_add_u32 s82, s81, 4
    s_and_b32 s82, s82, 31
    s_lshl_b32 s82, s82, 12
    s_add_u32 s82, s82, s80
    buffer_load_dwordx4 v[56:59], v2, s[40:43], s82 offen offset:0 nt
    buffer_load_dwordx4 v[60:63], v2, s[40:43], s82 offen offset:128 nt
    buffer_load_dwordx4 v[64:67], v2, s[40:43], s82 offen offset:2048 nt
    s_waitcnt vmcnt(6)
    buffer_load_dwordx4 v[68:71], v2, s[40:43], s82 offen offset:2176 nt
    s_add_u32 s82, s81, 8
    s_and_b32 s82, s82, 31
    s_lshl_b32 s82, s82, 12
    s_add_u32 s82, s82, s80
    s_waitcnt vmcnt(6)
    buffer_load_dwordx4 v[72:75], v2, s[40:43], s82 offen offset:0 nt
    s_waitcnt vmcnt(6)
    buffer_load_dwordx4 v[76:79], v2, s[40:43], s82 offen offset:128 nt
    s_waitcnt vmcnt(6)
    buffer_load_dwordx4 v[80:83], v2, s[40:43], s82 offen offset:2048 nt
    s_waitcnt vmcnt(6)
    buffer_load_dwordx4 v[84:87], v2, s[40:43], s82 offen offset:2176 nt
    s_add_u32 s82, s81, 12
    s_and_b32 s82, s82, 31
    s_lshl_b32 s82, s82, 12
    s_add_u32 s82, s82, s80
    s_waitcnt vmcnt(6)
    buffer_load_dwordx4 v[88:91], v2, s[40:43], s82 offen offset:0 nt
    s_waitcnt vmcnt(6)
    buffer_load_dwordx4 v[92:95], v2, s[40:43], s82 offen offset:128 nt
    s_waitcnt vmcnt(6)
    buffer_load_dwordx4 v[96:99], v2, s[40:43], s82 offen offset:2048 nt
    s_waitcnt vmcnt(6)
    buffer_load_dwordx4 v[100:103], v2, s[40:43], s82 offen offset:2176 nt
    s_add_u32 s82, s81, 16
    s_and_b32 s82, s82, 31
    s_lshl_b32 s82, s82, 12
    s_add_u32 s82, s82, s80
    s_waitcnt vmcnt(6)
    buffer_load_dwordx4 v[104:107], v2, s[40:43], s82 offen offset:0 nt
    v_mov_b32 v3, 0x2c78
    ds_write_b32 v3, v3
    s_waitcnt vmcnt(6)
    buffer_load_dwordx4 v[108:111], v2, s[40:43], s82 offen offset:128 nt
    s_waitcnt vmcnt(6)
    buffer_load_dwordx4 v[112:115], v2, s[40:43], s82 offen offset:2048 nt
    s_waitcnt vmcnt(6)
    buffer_load_dwordx4 v[116:119], v2, s[40:43], s82 offen offset:2176 nt
    s_add_u32 s82, s81, 20
    s_and_b32 s82, s82, 31
    s_lshl_b32 s82, s82, 12
    s_add_u32 s82, s82, s80
    s_waitcnt vmcnt(6)
    buffer_load_dwordx4 v[120:123], v2, s[40:43], s82 offen offset:0 nt
    s_waitcnt vmcnt(6)
    buffer_load_dwordx4 v[124:127], v2, s[40:43], s82 offen offset:128 nt
    s_waitcnt vmcnt(6)
    buffer_load_dwordx4 v[128:131], v2, s[40:43], s82 offen offset:2048 nt
    s_waitcnt vmcnt(6)
    buffer_load_dwordx4 v[132:135], v2, s[40:43], s82 offen offset:2176 nt
    s_add_u32 s82, s81, 24
    s_and_b32 s82, s82, 31
    s_lshl_b32 s82, s82, 12
    s_add_u32 s82, s82, s80
    s_waitcnt vmcnt(6)
    buffer_load_dwordx4 v[136:139], v2, s[40:43], s82 offen offset:0 nt
    s_waitcnt vmcnt(6)
    buffer_load_dwordx4 v[140:143], v2, s[40:43], s82 offen offset:128 nt
    s_waitcnt vmcnt(6)
    buffer_load_dwordx4 v[144:147], v2, s[40:43], s82 offen offset:2048 nt
    s_waitcnt vmcnt(6)
    buffer_load_dwordx4 v[148:151], v2, s[40:43], s82 offen offset:2176 nt
    s_add_u32 s82, s81, 28
    s_and_b32 s82, s82, 31
    s_lshl_b32 s82, s82, 12
    s_add_u32 s82, s82, s80
    s_waitcnt vmcnt(6)
    buffer_load_dwordx4 v[152:155], v2, s[40:43], s82 offen offset:0 nt
    s_waitcnt vmcnt(6)
    buffer_load_dwordx4 v[156:159], v2, s[40:43], s82 offen offset:128 nt
    s_waitcnt vmcnt(6)
    buffer_load_dwordx4 v[160:163], v2, s[40:43], s82 offen offset:2048 nt
    s_waitcnt vmcnt(6)
    buffer_load_dwordx4 v[164:167], v2, s[40:43], s82 offen offset:2176 nt
    s_branch K_vd
K_v2:
    s_add_u32 s82, s81, 0
    s_and_b32 s82, s82, 31
    s_lshl_b32 s82, s82, 12
    s_add_u32 s82, s82, s80
    buffer_load_dwordx4 v[40:43], v2, s[40:43], s82 offen offset:0 nt
    buffer_load_dwordx4 v[44:47], v2, s[40:43], s82 offen offset:128 nt
    buffer_load_dwordx4 v[48:51], v2, s[40:43], s82 offen offset:2048 nt
    buffer_load_dwordx4 v[52:55], v2, s[40:43], s82 offen offset:2176 nt
    s_add_u32 s82, s81, 4
    s_and_b32 s82, s82, 31
    s_lshl_b32 s82, s82, 12
    s_add_u32 s82, s82, s80
    buffer_load_dwordx4 v[56:59], v2, s[40:43], s82 offen offset:0 nt
    buffer_load_dwordx4 v[60:63], v2, s[40:43], s82 offen offset:128 nt
    buffer_load_dwordx4 v[64:67], v2, s[40:43], s82 offen offset:2048 nt
    buffer_load_dwordx4 v[68:71], v2, s[40:43], s82 offen offset:2176 nt
    s_add_u32 s82, s81, 8
    s_and_b32 s82, s82, 31
    s_lshl_b32 s82, s82, 12
    s_add_u32 s82, s82, s80
    s_waitcnt vmcnt(7)
    buffer_load_dwordx4 v[72:75], v2, s[40:43], s82 offen offset:0 nt
    s_waitcnt vmcnt(7)
    buffer_load_dwordx4 v[76:79], v2, s[40:43], s82 offen offset:128 nt
    s_waitcnt vmcnt(7)
    buffer_load_dwordx4 v[80:83], v2, s[40:43], s82 offen offset:2048 nt
    s_waitcnt vmcnt(7)
    buffer_load_dwordx4 v[84:87], v2, s[40:43], s82 offen offset:2176 nt
    s_add_u32 s82, s81, 12
    s_and_b32 s82, s82, 31
    s_lshl_b32 s82, s82, 12
    s_add_u32 s82, s82, s80
    s_waitcnt vmcnt(7)
    buffer_load_dwordx4 v[88:91], v2, s[40:43], s82 offen offset:0 nt
    s_waitcnt vmcnt(7)
    buffer_load_dwordx4 v[92:95], v2, s[40:43], s82 offen offset:128 nt
    s_waitcnt vmcnt(7)
    buffer_load_dwordx4 v[96:99], v2, s[40:43], s82 offen offset:2048 nt
    s_waitcnt vmcnt(7)
    buffer_load_dwordx4 v[100:103], v2, s[40:43], s82 offen offset:2176 nt
    s_add_u32 s82, s81, 16
    s_and_b32 s82, s82, 31
    s_lshl_b32 s82, s82, 12
    s_add_u32 s82, s82, s80
    s_waitcnt vmcnt(7)
    buffer_load_dwordx4 v[104:107], v2, s[40:43], s82 offen offset:0 nt
    v_mov_b32 v3, 0x2c78
    ds_write_b32 v3, v3
    s_waitcnt vmcnt(7)
    buffer_load_dwordx4 v[108:111], v2, s[40:43], s82 offen offset:128 nt
    s_waitcnt vmcnt(7)
    buffer_load_dwordx4 v[112:115], v2, s[40:43], s82 offen offset:2048 nt
    s_waitcnt vmcnt(7)
    buffer_load_dwordx4 v[116:119], v2, s[40:43], s82 offen offset:2176 nt
    s_add_u32 s82, s81, 20
    s_and_b32 s82, s82, 31
    s_lshl_b32 s82, s82, 12
    s_add_u32 s82, s82, s80
    s_waitcnt vmcnt(7)
    buffer_load_dwordx4 v[120:123], v2, s[40:43], s82 offen offset:0 nt
    s_waitcnt vmcnt(7)
    buffer_load_dwordx4 v[124:127], v2, s[40:43], s82 offen offset:128 nt
    s_waitcnt vmcnt(7)
    buffer_load_dwordx4 v[128:131], v2, s[40:43], s82 offen offset:2048 nt
    s_waitcnt vmcnt(7)
    buffer_load_dwordx4 v[132:135], v2, s[40:43], s82 offen offset:2176 nt
    s_add_u32 s82, s81, 24
    s_and_b32 s82, s82, 31
    s_lshl_b32 s82, s82, 12
    s_add_u32 s82, s82, s80
    s_waitcnt vmcnt(7)
    buffer_load_dwordx4 v[136:139], v2, s[40:43], s82 offen offset:0 nt
    s_waitcnt vmcnt(7)
    buffer_load_dwordx4 v[140:143], v2, s[40:43], s82 offen offset:128 nt
    s_waitcnt vmcnt(7)
    buffer_load_dwordx4 v[144:147], v2, s[40:43], s82 offen offset:2048 nt
    s_waitcnt vmcnt(7)
    buffer_load_dwordx4 v[148:151], v2, s[40:43], s82 offen offset:2176 nt
    s_add_u32 s82, s81, 28
    s_and_b32 s82, s82, 31
    s_lshl_b32 s82, s82, 12
    s_add_u32 s82, s82, s80
    s_waitcnt vmcnt(7)
    buffer_load_dwordx4 v[152:155], v2, s[40:43], s82 offen offset:0 nt
    s_waitcnt vmcnt(7)
    buffer_load_dwordx4 v[156:159], v2, s[40:43], s82 offen offset:128 nt
    s_waitcnt vmcnt(7)
    buffer_load_dwordx4 v[160:163], v2, s[40:43], s82 offen offset:2048 nt
    s_waitcnt vmcnt(7)
    buffer_load_dwordx4 v[164:167], v2, s[40:43], s82 offen offset:2176 nt
    s_branch K_vd
K_vq:
    s_add_u32 s82, s81, 0
    s_and_b32 s82, s82, 31
    s_lshl_b32 s82, s82, 12
    s_add_u32 s82, s82, s80
    buffer_load_dwordx4 v[40:43], v2, s[40:43], s82 offen offset:0 nt
    buffer_load_dwordx4 v[44:47], v2, s[40:43], s82 offen offset:128 nt
    buffer_load_dwordx4 v[48:51], v2, s[40:43], s82 offen offset:2048 nt
    buffer_load_dwordx4 v[52:55], v2, s[40:43], s82 offen offset:2176 nt
    s_add_u32 s82, s81, 4
    s_and_b32 s82, s82, 31
    s_lshl_b32 s82, s82, 12
    s_add_u32 s82, s82, s80
    buffer_load_dwordx4 v[56:59], v2, s[40:43], s82 offen offset:0 nt
    buffer_load_dwordx4 v[60:63], v2, s[40:43], s82 offen offset:128 nt
    buffer_load_dwordx4 v[64:67], v2, s[40:43], s82 offen offset:2048 nt
    buffer_load_dwordx4 v[68:71], v2, s[40:43], s82 offen offset:2176 nt
    s_add_u32 s82, s81, 8
    s_and_b32 s82, s82, 31
    s_lshl_b32 s82, s82, 12
    s_add_u32 s82, s82, s80
    s_waitcnt vmcnt(7)
    buffer_load_dwordx4 v[72:75], v2, s[40:43], s82 offen offset:0 nt
    s_waitcnt vmcnt(7)
    buffer_load_dwordx4 v[76:79], v2, s[40:43], s82 offen offset:128 nt
    v_mov_b32 v3, 0x2e20
    s_mov_b32 s78, 400000
P_119:
    ds_read_b128 v[8:11], v3
    s_waitcnt lgkmcnt(0)
    v_max3_u32 v12, v8, v9, v10
    v_max_u32 v12, v12, v11
    v_cmp_eq_u32 vcc, -1, v12
    s_cbranch_vccz PD_118
    s_sub_u32 s78, s78, 1
    s_cbranch_scc0 P_119
PD_118:
    s_nop 0
    s_waitcnt vmcnt(7)
    buffer_load_dwordx4 v[80:83], v2, s[40:43], s82 offen offset:2048 nt
    s_waitcnt vmcnt(7)
    buffer_load_dwordx4 v[84:87], v2, s[40:43], s82 offen offset:2176 nt
    s_add_u32 s82, s81, 12
    s_and_b32 s82, s82, 31
    s_lshl_b32 s82, s82, 12
    s_add_u32 s82, s82, s80
    s_waitcnt vmcnt(7)
    buffer_load_dwordx4 v[88:91], v2, s[40:43], s82 offen offset:0 nt
    s_waitcnt vmcnt(7)
    buffer_load_dwordx4 v[92:95], v2, s[40:43], s82 offen offset:128 nt
    s_waitcnt vmcnt(7)
    buffer_load_dwordx4 v[96:99], v2, s[40:43], s82 offen offset:2048 nt
    s_waitcnt vmcnt(7)
    buffer_load_dwordx4 v[100:103], v2, s[40:43], s82 offen offset:2176 nt
    s_add_u32 s82, s81, 16
    s_and_b32 s82, s82, 31
    s_lshl_b32 s82, s82, 12
    s_add_u32 s82, s82, s80
    s_waitcnt vmcnt(7)
    buffer_load_dwordx4 v[104:107], v2, s[40:43], s82 offen offset:0 nt
    v_mov_b32 v3, 0x2c78
    ds_write_b32 v3, v3
    s_waitcnt vmcnt(7)
    buffer_load_dwordx4 v[108:111], v2, s[40:43], s82 offen offset:128 nt
    s_waitcnt vmcnt(7)
    buffer_load_dwordx4 v[112:115], v2, s[40:43], s82 offen offset:2048 nt
    s_waitcnt vmcnt(7)
    buffer_load_dwordx4 v[116:119], v2, s[40:43], s82 offen offset:2176 nt
    s_add_u32 s82, s81, 20
    s_and_b32 s82, s82, 31
    s_lshl_b32 s82, s82, 12
    s_add_u32 s82, s82, s80
    v_mov_b32 v3, 0x2c60
    s_mov_b32 s78, 400000
P_122:
    ds_read_b128 v[8:11], v3
    s_waitcnt lgkmcnt(0)
    v_max3_u32 v12, v8, v9, v10
    v_max_u32 v12, v12, v11
    v_cmp_eq_u32 vcc, -1, v12
    s_cbranch_vccz PD_121
    s_sub_u32 s78, s78, 1
    s_cbranch_scc0 P_122
PD_121:
    s_nop 0
    s_waitcnt vmcnt(7)
    buffer_load_dwordx4 v[120:123], v2, s[40:43], s82 offen offset:0 nt
    s_waitcnt vmcnt(7)
    buffer_load_dwordx4 v[124:127], v2, s[40:43], s82 offen offset:128 nt
    s_waitcnt vmcnt(7)
    buffer_load_dwordx4 v[128:131], v2, s[40:43], s82 offen offset:2048 nt
    s_waitcnt vmcnt(7)
    buffer_load_dwordx4 v[132:135], v2, s[40:43], s82 offen offset:2176 nt
    s_add_u32 s82, s81, 24
    s_and_b32 s82, s82, 31
    s_lshl_b32 s82, s82, 12
    s_add_u32 s82, s82, s80
    s_waitcnt vmcnt(7)
    buffer_load_dwordx4 v[136:139], v2, s[40:43], s82 offen offset:0 nt
    s_waitcnt vmcnt(7)
    buffer_load_dwordx4 v[140:143], v2, s[40:43], s82 offen offset:128 nt
    s_waitcnt vmcnt(7)
    buffer_load_dwordx4 v[144:147], v2, s[40:43], s82 offen offset:2048 nt
    s_waitcnt vmcnt(7)
    buffer_load_dwordx4 v[148:151], v2, s[40:43], s82 offen offset:2176 nt
    s_add_u32 s82, s81, 28
    s_and_b32 s82, s82, 31
    s_lshl_b32 s82, s82, 12
    s_add_u32 s82, s82, s80
    s_waitcnt vmcnt(7)
    buffer_load_dwordx4 v[152:155], v2, s[40:43], s82 offen offset:0 nt
    s_waitcnt vmcnt(7)
    buffer_load_dwordx4 v[156:159], v2, s[40:43], s82 offen offset:128 nt
    s_waitcnt vmcnt(7)
    buffer_load_dwordx4 v[160:163], v2, s[40:43], s82 offen offset:2048 nt
    s_waitcnt vmcnt(7)
    buffer_load_dwordx4 v[164:167], v2, s[40:43], s82 offen offset:2176 nt
    s_branch K_vd
K_vq7:
    s_add_u32 s82, s81, 0
    s_and_b32 s82, s82, 31
    s_lshl_b32 s82, s82, 12
    s_add_u32 s82, s82, s80
    buffer_load_dwordx4 v[40:43], v2, s[40:43], s82 offen offset:0 nt
    buffer_load_dwordx4 v[44:47], v2, s[40:43], s82 offen offset:128 nt
    buffer_load_dwordx4 v[48:51], v2, s[40:43], s82 offen offset:2048 nt
    buffer_load_dwordx4 v[52:55], v2, s[40:43], s82 offen offset:2176 nt
    s_add_u32 s82, s81, 4
    s_and_b32 s82, s82, 31
    s_lshl_b32 s82, s82, 12
    s_add_u32 s82, s82, s80
    buffer_load_dwordx4 v[56:59], v2, s[40:43], s82 offen offset:0 nt
    buffer_load_dwordx4 v[60:63], v2, s[40:43], s82 offen offset:128 nt
    buffer_load_dwordx4 v[64:67], v2, s[40:43], s82 offen offset:2048 nt
    buffer_load_dwordx4 v[68:71], v2, s[40:43], s82 offen offset:2176 nt
    s_add_u32 s82, s81, 8
    s_and_b32 s82, s82, 31
    s_lshl_b32 s82, s82, 12
    s_add_u32 s82, s82, s80
    s_waitcnt vmcnt(7)
    buffer_load_dwordx4 v[72:75], v2, s[40:43], s82 offen offset:0 nt
    s_waitcnt vmcnt(7)
    buffer_load_dwordx4 v[76:79], v2, s[40:43], s82 offen offset:128 nt
    s_waitcnt vmcnt(7)
    buffer_load_dwordx4 v[80:83], v2, s[40:43], s82 offen offset:2048 nt
    s_waitcnt vmcnt(7)
    buffer_load_dwordx4 v[84:87], v2, s[40:43], s82 offen offset:2176 nt
    s_add_u32 s82, s81, 12
    s_and_b32 s82, s82, 31
    s_lshl_b32 s82, s82, 12
    s_add_u32 s82, s82, s80
    v_mov_b32 v3, 0x2e20
    s_mov_b32 s78, 400000
P_125:
    ds_read_b128 v[8:11], v3
    s_waitcnt lgkmcnt(0)
    v_max3_u32 v12, v8, v9, v10
    v_max_u32 v12, v12, v11
    v_cmp_eq_u32 vcc, -1, v12
    s_cbranch_vccz PD_124
    s_sub_u32 s78, s78, 1
    s_cbranch_scc0 P_125
PD_124:
    s_nop 0
    s_waitcnt vmcnt(7)
    buffer_load_dwordx4 v[88:91], v2, s[40:43], s82 offen offset:0 nt
    s_waitcnt vmcnt(7)
    buffer_load_dwordx4 v[92:95], v2, s[40:43], s82 offen offset:128 nt
    s_waitcnt vmcnt(7)
    buffer_load_dwordx4 v[96:99], v2, s[40:43], s82 offen offset:2048 nt
    s_waitcnt vmcnt(7)
    buffer_load_dwordx4 v[100:103], v2, s[40:43], s82 offen offset:2176 nt
    s_add_u32 s82, s81, 16
    s_and_b32 s82, s82, 31
    s_lshl_b32 s82, s82, 12
    s_add_u32 s82, s82, s80
    s_waitcnt vmcnt(7)
    buffer_load_dwordx4 v[104:107], v2, s[40:43], s82 offen offset:0 nt
    v_mov_b32 v3, 0x2c78
    ds_write_b32 v3, v3
    s_waitcnt vmcnt(7)
    buffer_load_dwordx4 v[108:111], v2, s[40:43], s82 offen offset:128 nt
    s_waitcnt vmcnt(7)
    buffer_load_dwordx4 v[112:115], v2, s[40:43], s82 offen offset:2048 nt
    s_waitcnt vmcnt(7)
    buffer_load_dwordx4 v[116:119], v2, s[40:43], s82 offen offset:2176 nt
    s_add_u32 s82, s81, 20
    s_and_b32 s82, s82, 31
    s_lshl_b32 s82, s82, 12
    s_add_u32 s82, s82, s80
    s_waitcnt vmcnt(7)
    buffer_load_dwordx4 v[120:123], v2, s[40:43], s82 offen offset:0 nt
    s_waitcnt vmcnt(7)
    buffer_load_dwordx4 v[124:127], v2, s[40:43], s82 offen offset:128 nt
    s_waitcnt vmcnt(7)
    buffer_load_dwordx4 v[128:131], v2, s[40:43], s82 offen offset:2048 nt
    s_waitcnt vmcnt(7)
    buffer_load_dwordx4 v[132:135], v2, s[40:43], s82 offen offset:2176 nt
    s_add_u32 s82, s81, 24
    s_and_b32 s82, s82, 31
    s_lshl_b32 s82, s82, 12
    s_add_u32 s82, s82, s80
    s_waitcnt vmcnt(7)
    buffer_load_dwordx4 v[136:139], v2, s[40:43], s82 offen offset:0 nt
    s_waitcnt vmcnt(7)
    buffer_load_dwordx4 v[140:143], v2, s[40:43], s82 offen offset:128 nt
    s_waitcnt vmcnt(7)
    buffer_load_dwordx4 v[144:147], v2, s[40:43], s82 offen offset:2048 nt
    s_waitcnt vmcnt(7)
    buffer_load_dwordx4 v[148:151], v2, s[40:43], s82 offen offset:2176 nt
    s_add_u32 s82, s81, 28
    s_and_b32 s82, s82, 31
    s_lshl_b32 s82, s82, 12
    s_add_u32 s82, s82, s80
    s_waitcnt vmcnt(7)
    buffer_load_dwordx4 v[152:155], v2, s[40:43], s82 offen offset:0 nt
    s_waitcnt vmcnt(7)
    buffer_load_dwordx4 v[156:159], v2, s[40:43], s82 offen offset:128 nt
    s_waitcnt vmcnt(7)
    buffer_load_dwordx4 v[160:163], v2, s[40:43], s82 offen offset:2048 nt
    s_waitcnt vmcnt(7)
    buffer_load_dwordx4 v[164:167], v2, s[40:43], s82 offen offset:2176 nt
K_vd:
    s_lshl_b32 s91, s76, 2
    s_add_u32 s91, s91, 0x2c00
    v_mov_b32 v3, s91
    v_mov_b32 v4, 1
    ds_write_b32 v3, v4
    s_setprio 0
    v_bfe_u32 v5, v1, 4, 2
    v_lshlrev_b32 v5, 6, v5
    v_bfe_u32 v4, v1, 0, 2
    v_lshl_add_u32 v5, v4, 4, v5
    v_bfe_u32 v4, v1, 2, 2
    v_lshl_add_u32 v5, v4, 2, v5
    s_lshl_b32 s83, s76, 10
    v_add_u32 v5, s83, v5
    s_lshl_b32 s83, s76, 5
    v_lshlrev_b32 v6, 3, v1
    v_add_u32 v6, s83, v6
    v_bfe_u32 v3, v1, 0, 2
    v_lshlrev_b32 v3, 8, v3
    v_bfe_u32 v4, v1, 2, 1
    v_lshl_add_u32 v3, v4, 6, v3
    v_bfe_u32 v4, v1, 4, 2
    v_lshl_add_u32 v3, v4, 4, v3
    s_mov_b32 s78, 400000
P_128:
    ds_read_b128 v[8:11], v3 offset:6144
    ds_read_b128 v[12:15], v3 offset:6272
    s_waitcnt lgkmcnt(0)
    v_max3_u32 v4, v8, v9, v10
    v_max3_u32 v4, v4, v11, v12
    v_max3_u32 v4, v4, v13, v14
    v_max_u32 v4, v4, v15
    v_cmp_eq_u32 vcc, -1, v4
    s_cbranch_vccz PD_127
    s_sub_u32 s78, s78, 1
    s_cbranch_scc0 P_128
PD_127:
    s_nop 0
    s_setprio 3
    s_waitcnt vmcnt(28)
    v_mfma_f32_16x16x32_bf16 v[16:19], v[40:43], v[8:11], 0
    v_mfma_f32_16x16x32_bf16 v[16:19], v[44:47], v[12:15], v[16:19]
    v_mfma_f32_16x16x32_bf16 v[20:23], v[48:51], v[8:11], 0
    v_mfma_f32_16x16x32_bf16 v[20:23], v[52:55], v[12:15], v[20:23]
    s_waitcnt vmcnt(24)
    v_mfma_f32_16x16x32_bf16 v[32:35], v[56:59], v[8:11], 0
    v_mfma_f32_16x16x32_bf16 v[32:35], v[60:63], v[12:15], v[32:35]
    s_nop 2
    v_add_f32_dpp v24, v17, v16 row_ror:12 row_mask:0xf bank_mask:0x1
    v_add_f32_dpp v25, v19, v18 row_ror:12 row_mask:0xf bank_mask:0x1
    v_mfma_f32_16x16x32_bf16 v[36:39], v[64:67], v[8:11], 0
    v_mfma_f32_16x16x32_bf16 v[36:39], v[68:71], v[12:15], v[36:39]
    v_add_f32_dpp v24, v20, v21 row_ror:4 row_mask:0xf bank_mask:0x2
    v_add_f32_dpp v25, v22, v23 row_ror:4 row_mask:0xf bank_mask:0x2
    s_waitcnt vmcnt(20)
    v_mfma_f32_16x16x32_bf16 v[16:19], v[72:75], v[8:11], 0
    v_mfma_f32_16x16x32_bf16 v[16:19], v[76:79], v[12:15], v[16:19]
    v_add_f32_dpp v24, v33, v32 row_ror:12 row_mask:0xf bank_mask:0x4
    v_add_f32_dpp v25, v35, v34 row_ror:12 row_mask:0xf bank_mask:0x4
    v_mfma_f32_16x16x32_bf16 v[20:23], v[80:83], v[8:11], 0
    v_mfma_f32_16x16x32_bf16 v[20:23], v[84:87], v[12:15], v[20:23]
    v_add_f32_dpp v24, v36, v37 row_ror:4 row_mask:0xf bank_mask:0x8
    v_add_f32_dpp v25, v38, v39 row_ror:4 row_mask:0xf bank_mask:0x8
    s_waitcnt vmcnt(16)
    v_mfma_f32_16x16x32_bf16 v[32:35], v[88:91], v[8:11], 0
    v_mfma_f32_16x16x32_bf16 v[32:35], v[92:95], v[12:15], v[32:35]
    v_add_f32_dpp v26, v17, v16 row_ror:12 row_mask:0xf bank_mask:0x1
    v_add_f32_dpp v27, v19, v18 row_ror:12 row_mask:0xf bank_mask:0x1
    v_mfma_f32_16x16x32_bf16 v[36:39], v[96:99], v[8:11], 0
    v_mfma_f32_16x16x32_bf16 v[36:39], v[100:103], v[12:15], v[36:39]
    v_add_f32_dpp v26, v20, v21 row_ror:4 row_mask:0xf bank_mask:0x2
    v_add_f32_dpp v27, v22, v23 row_ror:4 row_mask:0xf bank_mask:0x2
    s_waitcnt vmcnt(12)
    v_mfma_f32_16x16x32_bf16 v[16:19], v[104:107], v[8:11], 0
    v_mfma_f32_16x16x32_bf16 v[16:19], v[108:111], v[12:15], v[16:19]
    v_add_f32_dpp v26, v33, v32 row_ror:12 row_mask:0xf bank_mask:0x4
    v_add_f32_dpp v27, v35, v34 row_ror:12 row_mask:0xf bank_mask:0x4
    v_mfma_f32_16x16x32_bf16 v[20:23], v[112:115], v[8:11], 0
    v_mfma_f32_16x16x32_bf16 v[20:23], v[116:119], v[12:15], v[20:23]
    v_add_f32_dpp v26, v36, v37 row_ror:4 row_mask:0xf bank_mask:0x8
    v_add_f32_dpp v27, v38, v39 row_ror:4 row_mask:0xf bank_mask:0x8
    s_waitcnt vmcnt(8)
    v_mfma_f32_16x16x32_bf16 v[32:35], v[120:123], v[8:11], 0
    v_mfma_f32_16x16x32_bf16 v[32:35], v[124:127], v[12:15], v[32:35]
    v_add_f32_dpp v28, v17, v16 row_ror:12 row_mask:0xf bank_mask:0x1
    v_add_f32_dpp v29, v19, v18 row_ror:12 row_mask:0xf bank_mask:0x1
    v_mfma_f32_16x16x32_bf16 v[36:39], v[128:131], v[8:11], 0
    v_mfma_f32_16x16x32_bf16 v[36:39], v[132:135], v[12:15], v[36:39]
    v_add_f32_dpp v28, v20, v21 row_ror:4 row_mask:0xf bank_mask:0x2
    v_add_f32_dpp v29, v22, v23 row_ror:4 row_mask:0xf bank_mask:0x2
    s_waitcnt vmcnt(4)
    v_mfma_f32_16x16x32_bf16 v[16:19], v[136:139], v[8:11], 0
    v_mfma_f32_16x16x32_bf16 v[16:19], v[140:143], v[12:15], v[16:19]
    v_add_f32_dpp v28, v33, v32 row_ror:12 row_mask:0xf bank_mask:0x4
    v_add_f32_dpp v29, v35, v34 row_ror:12 row_mask:0xf bank_mask:0x4
    v_mfma_f32_16x16x32_bf16 v[20:23], v[144:147], v[8:11], 0
    v_mfma_f32_16x16x32_bf16 v[20:23], v[148:151], v[12:15], v[20:23]
    v_add_f32_dpp v28, v36, v37 row_ror:4 row_mask:0xf bank_mask:0x8
    v_add_f32_dpp v29, v38, v39 row_ror:4 row_mask:0xf bank_mask:0x8
    s_waitcnt vmcnt(0)
    v_mfma_f32_16x16x32_bf16 v[32:35], v[152:155], v[8:11], 0
    v_mfma_f32_16x16x32_bf16 v[32:35], v[156:159], v[12:15], v[32:35]
    v_add_f32_dpp v30, v17, v16 row_ror:12 row_mask:0xf bank_mask:0x1
    v_add_f32_dpp v31, v19, v18 row_ror:12 row_mask:0xf bank_mask:0x1
    v_mfma_f32_16x16x32_bf16 v[36:39], v[160:163], v[8:11], 0
    v_mfma_f32_16x16x32_bf16 v[36:39], v[164:167], v[12:15], v[36:39]
    v_add_f32_dpp v30, v20, v21 row_ror:4 row_mask:0xf bank_mask:0x2
    v_add_f32_dpp v31, v22, v23 row_ror:4 row_mask:0xf bank_mask:0x2
    s_nop 1
    v_add_f32_dpp v30, v33, v32 row_ror:12 row_mask:0xf bank_mask:0x4
    v_add_f32_dpp v31, v35, v34 row_ror:12 row_mask:0xf bank_mask:0x4
    s_nop 1
    v_add_f32_dpp v30, v36, v37 row_ror:4 row_mask:0xf bank_mask:0x8
    v_add_f32_dpp v31, v38, v39 row_ror:4 row_mask:0xf bank_mask:0x8
    v_cvt_pk_bf16_f32 v24, 0, v24
    v_cvt_pk_bf16_f32 v25, 0, v25
    v_cvt_pk_bf16_f32 v26, 0, v26
    v_cvt_pk_bf16_f32 v27, 0, v27
    v_cvt_pk_bf16_f32 v28, 0, v28
    v_cvt_pk_bf16_f32 v29, 0, v29
    v_cvt_pk_bf16_f32 v30, 0, v30
    v_cvt_pk_bf16_f32 v31, 0, v31
    v_mul_f32 v24, 0x3db504f3, v24
    v_mul_f32 v25, 0x3db504f3, v25
    v_mul_f32 v26, 0x3db504f3, v26
    v_mul_f32 v27, 0x3db504f3, v27
    v_mul_f32 v28, 0x3db504f3, v28
    v_mul_f32 v29, 0x3db504f3, v29
    v_mul_f32 v30, 0x3db504f3, v30
    v_mul_f32 v31, 0x3db504f3, v31
    v_cvt_pk_bf16_f32 v24, 0, v24
    v_cvt_pk_bf16_f32 v25, 0, v25
    v_cvt_pk_bf16_f32 v26, 0, v26
    v_cvt_pk_bf16_f32 v27, 0, v27
    v_cvt_pk_bf16_f32 v28, 0, v28
    v_cvt_pk_bf16_f32 v29, 0, v29
    v_cvt_pk_bf16_f32 v30, 0, v30
    v_cvt_pk_bf16_f32 v31, 0, v31
    v_max3_f32 v32, v24, v25, v26
    v_max3_f32 v33, v27, v28, v29
    v_max3_f32 v32, v32, v30, v31
    v_max_f32 v32, v32, v33
    s_nop 1
    v_max_f32_dpp v32, v32, v32 row_ror:4 row_mask:0xf bank_mask:0xf
    s_nop 1
    v_max_f32_dpp v32, v32, v32 row_ror:8 row_mask:0xf bank_mask:0xf
    v_mov_b32 v34, v32
    s_nop 1
    v_permlane32_swap_b32 v34, v32
    v_max_f32 v32, v32, v34
    v_mov_b32 v34, v32
    s_nop 1
    v_permlane16_swap_b32 v34, v32
    v_max_f32 v32, v32, v34
    v_sub_f32 v24, v24, v32
    v_sub_f32 v25, v25, v32
    v_sub_f32 v26, v26, v32
    v_sub_f32 v27, v27, v32
    v_sub_f32 v28, v28, v32
    v_sub_f32 v29, v29, v32
    v_sub_f32 v30, v30, v32
    v_sub_f32 v31, v31, v32
    v_mul_f32 v24, 0x3fb8aa3b, v24
    v_mul_f32 v25, 0x3fb8aa3b, v25
    v_mul_f32 v26, 0x3fb8aa3b, v26
    v_mul_f32 v27, 0x3fb8aa3b, v27
    v_mul_f32 v28, 0x3fb8aa3b, v28
    v_mul_f32 v29, 0x3fb8aa3b, v29
    v_mul_f32 v30, 0x3fb8aa3b, v30
    v_mul_f32 v31, 0x3fb8aa3b, v31
    v_exp_f32 v24, v24
    v_exp_f32 v25, v25
    v_exp_f32 v26, v26
    v_exp_f32 v27, v27
    v_exp_f32 v28, v28
    v_exp_f32 v29, v29
    v_exp_f32 v30, v30
    v_exp_f32 v31, v31
    v_cvt_pk_bf16_f32 v8, v24, v25
    v_cvt_pk_bf16_f32 v9, v26, v27
    v_cvt_pk_bf16_f32 v10, v28, v29
    v_cvt_pk_bf16_f32 v11, v30, v31
    v_min_u32 v8, 0xfffffffe, v8
    v_min_u32 v9, 0xfffffffe, v9
    v_min_u32 v10, 0xfffffffe, v10
    v_min_u32 v11, 0xfffffffe, v11
    ds_write_b32 v5, v8 offset:7168
    ds_write_b32 v5, v9 offset:7424
    ds_write_b32 v5, v10 offset:7680
    ds_write_b32 v5, v11 offset:7936
    v_add_f32 v33, v24, v25
    v_add_f32 v34, v26, v27
    v_add_f32 v35, v28, v29
    v_add_f32 v36, v30, v31
    v_add_f32 v33, v33, v34
    v_add_f32 v35, v35, v36
    v_add_f32 v33, v33, v35
    s_nop 1
    v_add_f32_dpp v33, v33, v33 row_ror:4 row_mask:0xf bank_mask:0xf
    s_nop 1
    v_add_f32_dpp v33, v33, v33 row_ror:8 row_mask:0xf bank_mask:0xf
    v_mov_b32 v34, v33
    s_nop 1
    v_permlane32_swap_b32 v34, v33
    v_add_f32 v33, v33, v34
    v_mov_b32 v34, v33
    s_nop 1
    v_permlane16_swap_b32 v34, v33
    v_add_f32 v33, v33, v34
    v_min_u32 v32, 0xfffffffe, v32
    v_min_u32 v33, 0xfffffffe, v33
    s_mov_b64 exec, 15
    ds_write_b64 v6, v[32:33] offset:11392
    s_cmp_gt_u32 s76, 1
    s_cbranch_scc1 L_fin
    s_mov_b64 exec, -1
    s_setprio 1
    v_lshlrev_b32 v9, 2, v1
    s_cmp_eq_u32 s76, 0
    s_cbranch_scc1 K_m0
    s_cmp_lt_u32 s73, 16
    s_cbranch_scc1 L_fin
    s_branch K_ms
K_m0:
    v_mov_b32 v4, 0x2c74
    s_mov_b32 s78, 400000
P_131:
    ds_read_b32 v12, v4
    s_waitcnt lgkmcnt(0)
    v_cmp_eq_u32 vcc, -1, v12
    s_cbranch_vccz PD_130
    s_sub_u32 s78, s78, 1
    s_cbranch_scc0 P_131
PD_130:
    s_nop 0
    v_readfirstlane_b32 s79, v12
    v_bfe_u32 v4, v1, 0, 4
    v_lshlrev_b32 v4, 3, v4
    v_bfe_u32 v12, v1, 0, 5
    v_lshlrev_b32 v12, 3, v12
    v_mov_b32 v5, 0x2c10
    s_lshl_b32 s80, s74, 8
    s_add_u32 s80, s80, s77
    s_add_u32 s80, s80, 0x1000
    s_lshl_b32 s81, s75, 5
    s_add_u32 s81, s81, s80
    s_mov_b32 s78, 400000
P_134:
    ds_read_b64 v[16:17], v4 offset:11392
    ds_read_b32 v18, v5
    s_waitcnt lgkmcnt(0)
    v_max3_u32 v19, v16, v17, v18
    v_cmp_eq_u32 vcc, -1, v19
    s_cbranch_vccz PD_133
    s_sub_u32 s78, s78, 1
    s_cbranch_scc0 P_134
PD_133:
    s_nop 0
    v_max_f32_dpp v18, v16, v16 row_ror:4 row_mask:0xf bank_mask:0xf
    s_nop 1
    v_max_f32_dpp v18, v18, v18 row_ror:8 row_mask:0xf bank_mask:0xf
    v_sub_f32 v16, v16, v18
    v_mul_f32 v16, 0x3fb8aa3b, v16
    v_exp_f32 v16, v16
    s_nop 0
    v_mul_f32 v19, v16, v17
    s_nop 1
    v_add_f32_dpp v19, v19, v19 row_ror:4 row_mask:0xf bank_mask:0xf
    s_nop 1
    v_add_f32_dpp v19, v19, v19 row_ror:8 row_mask:0xf bank_mask:0xf
    v_min_u32 v16, 0xfffffffe, v16
    s_mov_b64 exec, 0xffff
    ds_write_b32 v9, v16 offset:11520
    s_mov_b64 exec, 15
    s_cmp_eq_u32 s79, 1
    s_cbranch_scc0 SLOW_135
    buffer_store_dwordx2 v[18:19], v4, s[32:35], s81 offen
BACK_136:
    s_nop 0
    s_mov_b64 exec, -1
    s_cmp_lt_u32 s73, 16
    s_cbranch_scc1 L_fin
K_ms:
    s_lshl_b32 s81, s76, 9
    s_add_u32 s80, s81, s77
    s_add_u32 s80, s80, 0x1000
    v_lshlrev_b32 v12, 3, v1
    s_lshl_b32 s81, s76, 8
    v_add_u32 v9, s81, v9
    s_mov_b32 s78, 40000
P_139:
    buffer_load_dwordx2 v[16:17], v12, s[32:35], s80 offen sc1
    s_waitcnt vmcnt(0)
    v_max_u32 v5, v16, v17
    v_cmp_eq_u32 vcc, -1, v5
    s_cbranch_vccz PD_138
    s_mov_b64 exec, vcc
    s_sub_u32 s78, s78, 1
    s_cbranch_scc0 P_139
PD_138:
    s_mov_b64 exec, s[92:93]
K_md:
    v_max_f32_dpp v18, v16, v16 row_ror:4 row_mask:0xf bank_mask:0xf
    s_nop 1
    v_max_f32_dpp v18, v18, v18 row_ror:8 row_mask:0xf bank_mask:0xf
    v_mov_b32 v20, v18
    s_nop 1
    v_permlane16_swap_b32 v20, v18
    v_max_f32 v18, v18, v20
    v_sub_f32 v16, v16, v18
    v_mul_f32 v16, 0x3fb8aa3b, v16
    v_exp_f32 v16, v16
    s_nop 0
    v_mul_f32 v19, v16, v17
    s_nop 1
    v_add_f32_dpp v19, v19, v19 row_ror:4 row_mask:0xf bank_mask:0xf
    s_nop 1
    v_add_f32_dpp v19, v19, v19 row_ror:8 row_mask:0xf bank_mask:0xf
    v_mov_b32 v20, v19
    s_nop 1
    v_permlane16_swap_b32 v20, v19
    v_add_f32 v19, v19, v20
    v_rcp_f32 v19, v19
    s_nop 0
    v_mul_f32 v16, v16, v19
    v_min_u32 v16, 0xfffffffe, v16
    ds_write_b32 v9, v16 offset:2560
    s_branch L_fin
L_v:
    v_lshlrev_b32 v2, 4, v1
    v_mov_b32 v4, -1
    v_mov_b32 v5, -1
    v_mov_b32 v6, -1
    v_mov_b32 v7, -1
    s_mul_i32 s83, s76, 5120
    v_add_u32 v3, s83, v2
    ds_write_b128 v3, v[4:7] offset:0
    ds_write_b128 v3, v[4:7] offset:1024
    ds_write_b128 v3, v[4:7] offset:2048
    ds_write_b128 v3, v[4:7] offset:3072
    ds_write_b128 v3, v[4:7] offset:4096
    s_lshl_b32 s83, s73, 2
    s_add_u32 s83, s83, s76
    s_mul_i32 s83, s83, 4096
    s_add_u32 s83, s83, s77
    s_and_b32 s85, s73, 1
    s_lshl_b32 s86, s72, 1
    s_add_u32 s85, s85, s86
    s_lshl_b32 s86, s85, 10
    s_add_u32 s86, s86, 0x4000
    s_lshl_b32 s85, s85, 9
    s_lshr_b32 s87, s73, 1
    s_lshl_b32 s87, s87, 14
    s_add_u32 s85, s85, s87
    s_add_u32 s85, s85, 0x8000
    v_bfe_u32 v8, v1, 5, 1
    v_lshlrev_b32 v8, 13, v8
    v_bfe_u32 v9, v1, 0, 5
    v_lshl_add_u32 v8, v9, 4, v8
    s_waitcnt lgkmcnt(0)
    s_mov_b32 s32, s30
    s_mov_b32 s33, s31
    s_mov_b32 s34, 0x800000
    s_mov_b32 s35, 0x20000
    s_mov_b32 s36, s28
    s_mov_b32 s37, s29
    s_mov_b32 s38, 0x100
    s_mov_b32 s39, 0x20000
    s_cmp_lg_u32 s76, 2
    s_cbranch_scc1 V_npt
    s_mov_b64 exec, 1
    buffer_load_dword v10, v2, s[36:39], 0 offen offset:192
    s_mov_b64 exec, -1
V_npt:
    s_cmp_ge_u32 s73, 4
    s_cbranch_scc1 V_noj
    s_cmp_lg_u32 s76, 0
    s_cbranch_scc1 V_j1
    buffer_store_dwordx4 v[4:7], v8, s[32:35], s85 offen sc1
V_j1:
    s_cmp_lg_u32 s76, 1
    s_cbranch_scc1 V_j2
    buffer_store_dwordx4 v[4:7], v2, s[32:35], s86 offen sc1
V_j2:
    buffer_store_dwordx4 v[4:7], v2, s[32:35], s83 offen offset:0 sc1
    buffer_store_dwordx4 v[4:7], v2, s[32:35], s83 offen offset:1024 sc1
    buffer_store_dwordx4 v[4:7], v2, s[32:35], s83 offen offset:2048 sc1
    buffer_store_dwordx4 v[4:7], v2, s[32:35], s83 offen offset:3072 sc1
V_noj:
    s_barrier
    s_mov_b32 s36, s28
    s_mov_b32 s37, s29
    s_mov_b32 s38, 0x100
    s_mov_b32 s39, 0x20000
    s_mov_b32 s40, s8
    s_mov_b32 s41, s9
    s_mov_b32 s42, 0x8000000
    s_mov_b32 s43, 0x20000
    s_cmp_ge_u32 s73, 4
    s_cbranch_scc1 V_noj2
    s_waitcnt vmcnt(0)
    s_lshl_b32 s91, s76, 2
    s_add_u32 s91, s91, 0x2c30
    v_mov_b32 v3, s91
    v_mov_b32 v8, 1
    ds_write_b32 v3, v8
    s_cmp_lg_u32 s76, 0
    s_cbranch_scc1 V_noj2
    v_mov_b32 v3, 0x2c30
    s_mov_b32 s78, 400000
P_142:
    ds_read_b128 v[8:11], v3
    s_waitcnt lgkmcnt(0)
    v_max3_u32 v12, v8, v9, v10
    v_max_u32 v12, v12, v11
    v_cmp_eq_u32 vcc, -1, v12
    s_cbranch_vccz PD_141
    s_sub_u32 s78, s78, 1
    s_cbranch_scc0 P_142
PD_141:
    s_nop 0
    s_lshl_b32 s83, s72, 2
    s_add_u32 s83, s83, s73
    s_lshl_b32 s83, s83, 2
    v_mov_b32 v3, 0
    s_mov_b64 exec, 1
    buffer_store_dword v8, v3, s[36:39], s83 offen sc1
    v_mov_b32 v13, 0x2e30
    s_mov_b32 s78, 400000
P_145:
    ds_read_b128 v[8:11], v13
    s_waitcnt lgkmcnt(0)
    v_max3_u32 v12, v8, v9, v10
    v_max_u32 v12, v12, v11
    v_cmp_eq_u32 vcc, -1, v12
    s_cbranch_vccz PD_144
    s_sub_u32 s78, s78, 1
    s_cbranch_scc0 P_145
PD_144:
    s_nop 0
    v_cmp_ge_u32 vcc, v8, v9
    s_nop 1
    v_cndmask_b32 v12, 0, 1, vcc
    v_cmp_ge_u32 vcc, v10, v11
    s_nop 1
    v_addc_co_u32 v12, vcc, 0, v12, vcc
    v_sub_u32 v9, 3, v12
    v_add_u32 v8, 1, v12
    s_cmp_ge_u32 s72, 4
    s_cselect_b64 vcc, -1, 0
    v_cndmask_b32 v8, v8, v9, vcc
    buffer_store_dword v8, v3, s[36:39], s83 offen offset:128 sc1
    s_mov_b64 exec, -1
V_noj2:
    s_lshl_b32 s84, s76, 10
    s_cmp_eq_u32 s76, 1
    s_cbranch_scc1 V_clr
    s_cmp_lg_u32 s76, 0
    s_cbranch_scc1 V_nodbg
    s_sub_u32 s83, s73, 4
    s_cmp_lt_u32 s83, 12
    s_cselect_b32 s83, 0, 56
    v_mov_b32 v3, s83
    s_mov_b32 s78, 400000
P_148:
    ds_read_b32 v8, v3 offset:11328
    s_waitcnt lgkmcnt(0)
    v_cmp_eq_u32 vcc, -1, v8
    s_cbranch_vccz PD_147
    s_sub_u32 s78, s78, 1
    s_cbranch_scc0 P_148
PD_147:
    s_nop 0
V_early:
    s_mov_b32 s78, 40000
    s_mov_b64 exec, 0xff
    s_cmp_ge_u32 s73, 16
    s_cselect_b32 exec_lo, 0xffff, exec_lo
P_149:
    buffer_load_dwordx4 v[8:11], v2, s[36:39], 0 offen sc1
    s_waitcnt vmcnt(0)
    v_min3_u32 v12, v8, v9, v10
    v_min_u32 v12, v12, v11
    v_cmp_eq_u32 vcc, 0, v12
    s_cbranch_vccz PD_150
    s_sub_u32 s78, s78, 1
    s_cbranch_scc0 P_149
PD_150:
    v_mov_b32 v3, 0x2c70
    v_add3_u32 v8, v8, v9, v10
    v_add_u32 v8, v8, v11
    s_nop 1
    v_add_u32_dpp v8, v8, v8 row_shr:1 row_mask:0xf bank_mask:0xf bound_ctrl:0
    s_nop 1
    v_add_u32_dpp v8, v8, v8 row_shr:2 row_mask:0xf bank_mask:0xf bound_ctrl:0
    s_nop 1
    v_add_u32_dpp v8, v8, v8 row_shr:4 row_mask:0xf bank_mask:0xf bound_ctrl:0
    v_min_u32 v8, 0xffff, v8
    s_mov_b64 exec, 0x80
    s_cmp_ge_u32 s73, 16
    s_cselect_b32 exec_lo, 0x8000, exec_lo
    ds_write_b32 v3, v8
    s_mov_b64 exec, 1
    s_getreg_b32 s85, hwreg(HW_REG_XCC_ID)
    s_and_b32 s85, s85, 0xf
    s_lshl_b32 s83, s73, 2
    s_add_u32 s83, s83, s77
    s_add_u32 s83, s83, 0x1400
    v_mov_b32 v8, s85
    buffer_store_dword v8, v2, s[32:35], s83 offen sc1
    s_mov_b64 exec, -1
    s_branch V_nodbg
V_clr:
    s_lshl_b32 s87, s72, 2
    s_add_u32 s87, s87, s74
    s_lshl_b32 s87, s87, 3
    s_add_u32 s87, s87, s75
    s_lshl_b32 s87, s87, 11
    s_add_u32 s87, s87, 0x100000
    buffer_store_dwordx4 v[4:7], v2, s[32:35], s87 offen sc1
    buffer_store_dwordx4 v[4:7], v2, s[32:35], s87 offen offset:1024 sc1
    s_waitcnt vmcnt(0)
    v_mov_b32 v3, 0x2c10
    ds_write_b32 v3, v3
V_nodbg:
    s_lshl_b32 s80, s74, 3
    s_add_u32 s80, s80, s72
    s_lshl_b32 s80, s80, 22
    s_lshl_b32 s81, s75, 17
    s_add_u32 s80, s80, s81
    s_add_u32 s80, s80, 0x300000
    s_mul_i32 s81, s72, 9
    s_mul_i32 s82, s74, 8
    s_add_u32 s81, s81, s82
    s_mul_i32 s82, s75, 5
    s_add_u32 s81, s81, s82
    s_mul_i32 s82, s76, 1
    s_add_u32 s81, s81, s82
    s_lshl_b32 s84, s76, 10
    s_lshl_b32 s90, s76, 14
    s_add_u32 s90, s90, 0x5000
    v_mov_b32 v32, 0
    v_mov_b32 v33, 0
    v_mov_b32 v34, 0
    v_mov_b32 v35, 0
    v_mov_b32 v36, 0
    v_mov_b32 v37, 0
    v_mov_b32 v38, 0
    v_mov_b32 v39, 0
    v_mov_b32 v40, 0
    v_mov_b32 v41, 0
    v_mov_b32 v42, 0
    v_mov_b32 v43, 0
    v_mov_b32 v44, 0
    v_mov_b32 v45, 0
    v_mov_b32 v46, 0
    v_mov_b32 v47, 0
    v_mov_b32 v48, 0
    v_mov_b32 v49, 0
    v_mov_b32 v50, 0
    v_mov_b32 v51, 0
    v_mov_b32 v52, 0
    v_mov_b32 v53, 0
    v_mov_b32 v54, 0
    v_mov_b32 v55, 0
    v_mov_b32 v56, 0
    v_mov_b32 v57, 0
    v_mov_b32 v58, 0
    v_mov_b32 v59, 0
    v_mov_b32 v60, 0
    v_mov_b32 v61, 0
    v_mov_b32 v62, 0
    v_mov_b32 v63, 0
    v_bfe_u32 v3, v1, 4, 1
    v_lshlrev_b32 v3, 5, v3
    v_xor_b32 v4, v2, v3
    v_xor_b32 v5, 64, v4
    v_xor_b32 v6, 128, v4
    v_xor_b32 v7, 192, v4
    v_bfe_u32 v64, v1, 2, 2
    v_lshlrev_b32 v64, 10, v64
    v_bfe_u32 v3, v1, 4, 2
    v_lshl_add_u32 v64, v3, 8, v64
    v_bfe_u32 v3, v1, 2, 2
    v_lshl_add_u32 v64, v3, 6, v64
    v_bfe_u32 v3, v1, 4, 1
    v_lshl_add_u32 v64, v3, 5, v64
    v_bfe_u32 v3, v1, 0, 2
    v_lshl_add_u32 v64, v3, 3, v64
    s_add_u32 s83, s90, 0x10000
    v_add_u32 v64, s83, v64
    v_xor_b32 v65, 32, v64
    v_xor_b32 v66, 64, v64
    v_xor_b32 v67, 96, v64
    v_xor_b32 v68, 128, v64
    v_xor_b32 v69, 160, v64
    v_xor_b32 v70, 192, v64
    v_xor_b32 v71, 224, v64
    s_lshl_b32 s91, s76, 2
    s_add_u32 s91, s91, 0x2c00
    v_mov_b32 v3, s91
    s_mov_b32 s78, 400000
P_153:
    ds_read_b32 v8, v3
    s_waitcnt lgkmcnt(0)
    v_cmp_eq_u32 vcc, -1, v8
    s_cbranch_vccz PD_152
    s_sub_u32 s78, s78, 1
    s_cbranch_scc0 P_153
PD_152:
    s_nop 0
    s_setprio 3
    s_sub_u32 s83, s73, 4
    s_cmp_lt_u32 s83, 8
    s_cbranch_scc1 V_v1
    s_cmp_ge_u32 s72, 8
    s_cbranch_scc1 V_v1
V_v0:
    s_add_u32 s82, s81, 0
    s_and_b32 s82, s82, 31
    s_lshl_b32 s82, s82, 12
    s_add_u32 s82, s82, s80
    s_add_u32 m0, s90, 0x10000
    s_nop 0
    buffer_load_dwordx4 v4, s[40:43], s82 offen offset:0 nt lds
    buffer_load_dwordx4 v5, s[40:43], s82 offen offset:1024 nt lds
    buffer_load_dwordx4 v6, s[40:43], s82 offen offset:2048 nt lds
    buffer_load_dwordx4 v7, s[40:43], s82 offen offset:3072 nt lds
    s_add_u32 s82, s81, 4
    s_and_b32 s82, s82, 31
    s_lshl_b32 s82, s82, 12
    s_add_u32 s82, s82, s80
    s_add_u32 m0, s90, 0x11000
    s_nop 0
    buffer_load_dwordx4 v4, s[40:43], s82 offen offset:0 nt lds
    buffer_load_dwordx4 v5, s[40:43], s82 offen offset:1024 nt lds
    buffer_load_dwordx4 v6, s[40:43], s82 offen offset:2048 nt lds
    s_waitcnt vmcnt(6)
    buffer_load_dwordx4 v7, s[40:43], s82 offen offset:3072 nt lds
    s_add_u32 s82, s81, 8
    s_and_b32 s82, s82, 31
    s_lshl_b32 s82, s82, 12
    s_add_u32 s82, s82, s80
    s_add_u32 m0, s90, 0x12000
    s_waitcnt vmcnt(6)
    buffer_load_dwordx4 v4, s[40:43], s82 offen offset:0 nt lds
    s_waitcnt vmcnt(6)
    buffer_load_dwordx4 v5, s[40:43], s82 offen offset:1024 nt lds
    s_waitcnt vmcnt(6)
    buffer_load_dwordx4 v6, s[40:43], s82 offen offset:2048 nt lds
    s_waitcnt lgkmcnt(0)
    ds_read_b64_tr_b16 v[72:73], v64 offset:0
    ds_read_b64_tr_b16 v[76:77], v65 offset:0
    ds_read_b64_tr_b16 v[80:81], v66 offset:0
    ds_read_b64_tr_b16 v[84:85], v67 offset:0
    ds_read_b64_tr_b16 v[88:89], v68 offset:0
    ds_read_b64_tr_b16 v[92:93], v69 offset:0
    ds_read_b64_tr_b16 v[96:97], v70 offset:0
    ds_read_b64_tr_b16 v[100:101], v71 offset:0
    s_waitcnt vmcnt(6)
    buffer_load_dwordx4 v7, s[40:43], s82 offen offset:3072 nt lds
    s_add_u32 s82, s81, 12
    s_and_b32 s82, s82, 31
    s_lshl_b32 s82, s82, 12
    s_add_u32 s82, s82, s80
    s_add_u32 m0, s90, 0x13000
    s_waitcnt vmcnt(6)
    buffer_load_dwordx4 v4, s[40:43], s82 offen offset:0 nt lds
    s_waitcnt vmcnt(6)
    buffer_load_dwordx4 v5, s[40:43], s82 offen offset:1024 nt lds
    s_waitcnt vmcnt(6)
    buffer_load_dwordx4 v6, s[40:43], s82 offen offset:2048 nt lds
    s_waitcnt lgkmcnt(0)
    ds_read_b64_tr_b16 v[74:75], v64 offset:4096
    ds_read_b64_tr_b16 v[78:79], v65 offset:4096
    ds_read_b64_tr_b16 v[82:83], v66 offset:4096
    ds_read_b64_tr_b16 v[86:87], v67 offset:4096
    ds_read_b64_tr_b16 v[90:91], v68 offset:4096
    ds_read_b64_tr_b16 v[94:95], v69 offset:4096
    ds_read_b64_tr_b16 v[98:99], v70 offset:4096
    ds_read_b64_tr_b16 v[102:103], v71 offset:4096
    s_waitcnt vmcnt(6)
    buffer_load_dwordx4 v7, s[40:43], s82 offen offset:3072 nt lds
    v_mov_b32 v3, 0x2c40
    s_mov_b32 s78, 400000
P_156:
    ds_read_b128 v[8:11], v3
    s_waitcnt lgkmcnt(0)
    v_max3_u32 v12, v8, v9, v10
    v_max_u32 v12, v12, v11
    v_cmp_eq_u32 vcc, -1, v12
    s_cbranch_vccz PD_155
    s_sub_u32 s78, s78, 1
    s_cbranch_scc0 P_156
PD_155:
    s_nop 0
    s_add_u32 s82, s81, 16
    s_and_b32 s82, s82, 31
    s_lshl_b32 s82, s82, 12
    s_add_u32 s82, s82, s80
    s_add_u32 m0, s90, 0x0
    s_waitcnt vmcnt(6)
    buffer_load_dwordx4 v4, s[40:43], s82 offen offset:0 nt lds
    s_waitcnt vmcnt(6)
    buffer_load_dwordx4 v5, s[40:43], s82 offen offset:1024 nt lds
    s_waitcnt vmcnt(6)
    buffer_load_dwordx4 v6, s[40:43], s82 offen offset:2048 nt lds
    s_waitcnt lgkmcnt(0)
    ds_read_b64_tr_b16 v[104:105], v64 offset:8192
    ds_read_b64_tr_b16 v[108:109], v65 offset:8192
    ds_read_b64_tr_b16 v[112:113], v66 offset:8192
    ds_read_b64_tr_b16 v[116:117], v67 offset:8192
    ds_read_b64_tr_b16 v[120:121], v68 offset:8192
    ds_read_b64_tr_b16 v[124:125], v69 offset:8192
    ds_read_b64_tr_b16 v[128:129], v70 offset:8192
    ds_read_b64_tr_b16 v[132:133], v71 offset:8192
    s_waitcnt vmcnt(6)
    buffer_load_dwordx4 v7, s[40:43], s82 offen offset:3072 nt lds
    s_add_u32 s82, s81, 20
    s_and_b32 s82, s82, 31
    s_lshl_b32 s82, s82, 12
    s_add_u32 s82, s82, s80
    s_add_u32 m0, s90, 0x1000
    s_waitcnt vmcnt(6)
    buffer_load_dwordx4 v4, s[40:43], s82 offen offset:0 nt lds
    s_waitcnt vmcnt(6)
    buffer_load_dwordx4 v5, s[40:43], s82 offen offset:1024 nt lds
    s_waitcnt vmcnt(6)
    buffer_load_dwordx4 v6, s[40:43], s82 offen offset:2048 nt lds
    s_waitcnt lgkmcnt(0)
    ds_read_b64_tr_b16 v[106:107], v64 offset:12288
    ds_read_b64_tr_b16 v[110:111], v65 offset:12288
    ds_read_b64_tr_b16 v[114:115], v66 offset:12288
    ds_read_b64_tr_b16 v[118:119], v67 offset:12288
    ds_read_b64_tr_b16 v[122:123], v68 offset:12288
    ds_read_b64_tr_b16 v[126:127], v69 offset:12288
    ds_read_b64_tr_b16 v[130:131], v70 offset:12288
    ds_read_b64_tr_b16 v[134:135], v71 offset:12288
    s_waitcnt vmcnt(6)
    buffer_load_dwordx4 v7, s[40:43], s82 offen offset:3072 nt lds
    s_add_u32 s82, s81, 24
    s_and_b32 s82, s82, 31
    s_lshl_b32 s82, s82, 12
    s_add_u32 s82, s82, s80
    s_add_u32 m0, s90, 0x2000
    s_waitcnt vmcnt(6)
    buffer_load_dwordx4 v4, s[40:43], s82 offen offset:0 nt lds
    s_waitcnt vmcnt(6)
    buffer_load_dwordx4 v5, s[40:43], s82 offen offset:1024 nt lds
    s_waitcnt vmcnt(6)
    buffer_load_dwordx4 v6, s[40:43], s82 offen offset:2048 nt lds
    v_subrev_u32 v64, 0x10000, v64
    v_subrev_u32 v65, 0x10000, v65
    v_subrev_u32 v66, 0x10000, v66
    v_subrev_u32 v67, 0x10000, v67
    v_subrev_u32 v68, 0x10000, v68
    v_subrev_u32 v69, 0x10000, v69
    v_subrev_u32 v70, 0x10000, v70
    v_subrev_u32 v71, 0x10000, v71
    s_waitcnt lgkmcnt(0)
    ds_read_b64_tr_b16 v[136:137], v64 offset:0
    ds_read_b64_tr_b16 v[140:141], v65 offset:0
    ds_read_b64_tr_b16 v[144:145], v66 offset:0
    ds_read_b64_tr_b16 v[148:149], v67 offset:0
    ds_read_b64_tr_b16 v[152:153], v68 offset:0
    ds_read_b64_tr_b16 v[156:157], v69 offset:0
    ds_read_b64_tr_b16 v[160:161], v70 offset:0
    ds_read_b64_tr_b16 v[164:165], v71 offset:0
    s_waitcnt vmcnt(6)
    buffer_load_dwordx4 v7, s[40:43], s82 offen offset:3072 nt lds
    s_add_u32 s82, s81, 28
    s_and_b32 s82, s82, 31
    s_lshl_b32 s82, s82, 12
    s_add_u32 s82, s82, s80
    s_add_u32 m0, s90, 0x3000
    s_waitcnt vmcnt(6)
    buffer_load_dwordx4 v4, s[40:43], s82 offen offset:0 nt lds
    s_waitcnt vmcnt(6)
    buffer_load_dwordx4 v5, s[40:43], s82 offen offset:1024 nt lds
    s_waitcnt vmcnt(6)
    buffer_load_dwordx4 v6, s[40:43], s82 offen offset:2048 nt lds
    s_waitcnt lgkmcnt(0)
    ds_read_b64_tr_b16 v[138:139], v64 offset:4096
    ds_read_b64_tr_b16 v[142:143], v65 offset:4096
    ds_read_b64_tr_b16 v[146:147], v66 offset:4096
    ds_read_b64_tr_b16 v[150:151], v67 offset:4096
    ds_read_b64_tr_b16 v[154:155], v68 offset:4096
    ds_read_b64_tr_b16 v[158:159], v69 offset:4096
    ds_read_b64_tr_b16 v[162:163], v70 offset:4096
    ds_read_b64_tr_b16 v[166:167], v71 offset:4096
    s_waitcnt vmcnt(6)
    buffer_load_dwordx4 v7, s[40:43], s82 offen offset:3072 nt lds
    s_branch V_vd
V_v1:
    s_add_u32 s82, s81, 0
    s_and_b32 s82, s82, 31
    s_lshl_b32 s82, s82, 12
    s_add_u32 s82, s82, s80
    s_add_u32 m0, s90, 0x10000
    s_nop 0
    buffer_load_dwordx4 v4, s[40:43], s82 offen offset:0 nt lds
    buffer_load_dwordx4 v5, s[40:43], s82 offen offset:1024 nt lds
    buffer_load_dwordx4 v6, s[40:43], s82 offen offset:2048 nt lds
    buffer_load_dwordx4 v7, s[40:43], s82 offen offset:3072 nt lds
    s_add_u32 s82, s81, 4
    s_and_b32 s82, s82, 31
    s_lshl_b32 s82, s82, 12
    s_add_u32 s82, s82, s80
    s_add_u32 m0, s90, 0x11000
    s_nop 0
    buffer_load_dwordx4 v4, s[40:43], s82 offen offset:0 nt lds
    buffer_load_dwordx4 v5, s[40:43], s82 offen offset:1024 nt lds
    buffer_load_dwordx4 v6, s[40:43], s82 offen offset:2048 nt lds
    buffer_load_dwordx4 v7, s[40:43], s82 offen offset:3072 nt lds
    s_add_u32 s82, s81, 8
    s_and_b32 s82, s82, 31
    s_lshl_b32 s82, s82, 12
    s_add_u32 s82, s82, s80
    s_add_u32 m0, s90, 0x12000
    s_waitcnt vmcnt(7)
    buffer_load_dwordx4 v4, s[40:43], s82 offen offset:0 nt lds
    s_waitcnt vmcnt(7)
    buffer_load_dwordx4 v5, s[40:43], s82 offen offset:1024 nt lds
    s_waitcnt vmcnt(7)
    buffer_load_dwordx4 v6, s[40:43], s82 offen offset:2048 nt lds
    s_waitcnt vmcnt(7)
    buffer_load_dwordx4 v7, s[40:43], s82 offen offset:3072 nt lds
    s_waitcnt lgkmcnt(0)
    ds_read_b64_tr_b16 v[72:73], v64 offset:0
    ds_read_b64_tr_b16 v[76:77], v65 offset:0
    ds_read_b64_tr_b16 v[80:81], v66 offset:0
    ds_read_b64_tr_b16 v[84:85], v67 offset:0
    ds_read_b64_tr_b16 v[88:89], v68 offset:0
    ds_read_b64_tr_b16 v[92:93], v69 offset:0
    ds_read_b64_tr_b16 v[96:97], v70 offset:0
    ds_read_b64_tr_b16 v[100:101], v71 offset:0
    s_add_u32 s82, s81, 12
    s_and_b32 s82, s82, 31
    s_lshl_b32 s82, s82, 12
    s_add_u32 s82, s82, s80
    s_add_u32 m0, s90, 0x13000
    s_waitcnt vmcnt(7)
    buffer_load_dwordx4 v4, s[40:43], s82 offen offset:0 nt lds
    s_waitcnt vmcnt(7)
    buffer_load_dwordx4 v5, s[40:43], s82 offen offset:1024 nt lds
    s_waitcnt vmcnt(7)
    buffer_load_dwordx4 v6, s[40:43], s82 offen offset:2048 nt lds
    s_waitcnt vmcnt(7)
    buffer_load_dwordx4 v7, s[40:43], s82 offen offset:3072 nt lds
    s_waitcnt lgkmcnt(0)
    ds_read_b64_tr_b16 v[74:75], v64 offset:4096
    ds_read_b64_tr_b16 v[78:79], v65 offset:4096
    ds_read_b64_tr_b16 v[82:83], v66 offset:4096
    ds_read_b64_tr_b16 v[86:87], v67 offset:4096
    ds_read_b64_tr_b16 v[90:91], v68 offset:4096
    ds_read_b64_tr_b16 v[94:95], v69 offset:4096
    ds_read_b64_tr_b16 v[98:99], v70 offset:4096
    ds_read_b64_tr_b16 v[102:103], v71 offset:4096
    v_mov_b32 v3, 0x2c40
    s_mov_b32 s78, 400000
P_159:
    ds_read_b128 v[8:11], v3
    s_waitcnt lgkmcnt(0)
    v_max3_u32 v12, v8, v9, v10
    v_max_u32 v12, v12, v11
    v_cmp_eq_u32 vcc, -1, v12
    s_cbranch_vccz PD_158
    s_sub_u32 s78, s78, 1
    s_cbranch_scc0 P_159
PD_158:
    s_nop 0
    s_add_u32 s82, s81, 16
    s_and_b32 s82, s82, 31
    s_lshl_b32 s82, s82, 12
    s_add_u32 s82, s82, s80
    s_add_u32 m0, s90, 0x0
    s_waitcnt vmcnt(7)
    buffer_load_dwordx4 v4, s[40:43], s82 offen offset:0 nt lds
    s_waitcnt vmcnt(7)
    buffer_load_dwordx4 v5, s[40:43], s82 offen offset:1024 nt lds
    s_waitcnt vmcnt(7)
    buffer_load_dwordx4 v6, s[40:43], s82 offen offset:2048 nt lds
    s_waitcnt vmcnt(7)
    buffer_load_dwordx4 v7, s[40:43], s82 offen offset:3072 nt lds
    s_waitcnt lgkmcnt(0)
    ds_read_b64_tr_b16 v[104:105], v64 offset:8192
    ds_read_b64_tr_b16 v[108:109], v65 offset:8192
    ds_read_b64_tr_b16 v[112:113], v66 offset:8192
    ds_read_b64_tr_b16 v[116:117], v67 offset:8192
    ds_read_b64_tr_b16 v[120:121], v68 offset:8192
    ds_read_b64_tr_b16 v[124:125], v69 offset:8192
    ds_read_b64_tr_b16 v[128:129], v70 offset:8192
    ds_read_b64_tr_b16 v[132:133], v71 offset:8192
    s_add_u32 s82, s81, 20
    s_and_b32 s82, s82, 31
    s_lshl_b32 s82, s82, 12
    s_add_u32 s82, s82, s80
    s_add_u32 m0, s90, 0x1000
    s_waitcnt vmcnt(7)
    buffer_load_dwordx4 v4, s[40:43], s82 offen offset:0 nt lds
    s_waitcnt vmcnt(7)
    buffer_load_dwordx4 v5, s[40:43], s82 offen offset:1024 nt lds
    s_waitcnt vmcnt(7)
    buffer_load_dwordx4 v6, s[40:43], s82 offen offset:2048 nt lds
    s_waitcnt vmcnt(7)
    buffer_load_dwordx4 v7, s[40:43], s82 offen offset:3072 nt lds
    s_waitcnt lgkmcnt(0)
    ds_read_b64_tr_b16 v[106:107], v64 offset:12288
    ds_read_b64_tr_b16 v[110:111], v65 offset:12288
    ds_read_b64_tr_b16 v[114:115], v66 offset:12288
    ds_read_b64_tr_b16 v[118:119], v67 offset:12288
    ds_read_b64_tr_b16 v[122:123], v68 offset:12288
    ds_read_b64_tr_b16 v[126:127], v69 offset:12288
    ds_read_b64_tr_b16 v[130:131], v70 offset:12288
    ds_read_b64_tr_b16 v[134:135], v71 offset:12288
    s_add_u32 s82, s81, 24
    s_and_b32 s82, s82, 31
    s_lshl_b32 s82, s82, 12
    s_add_u32 s82, s82, s80
    s_add_u32 m0, s90, 0x2000
    s_waitcnt vmcnt(7)
    buffer_load_dwordx4 v4, s[40:43], s82 offen offset:0 nt lds
    s_waitcnt vmcnt(7)
    buffer_load_dwordx4 v5, s[40:43], s82 offen offset:1024 nt lds
    s_waitcnt vmcnt(7)
    buffer_load_dwordx4 v6, s[40:43], s82 offen offset:2048 nt lds
    s_waitcnt vmcnt(7)
    buffer_load_dwordx4 v7, s[40:43], s82 offen offset:3072 nt lds
    v_subrev_u32 v64, 0x10000, v64
    v_subrev_u32 v65, 0x10000, v65
    v_subrev_u32 v66, 0x10000, v66
    v_subrev_u32 v67, 0x10000, v67
    v_subrev_u32 v68, 0x10000, v68
    v_subrev_u32 v69, 0x10000, v69
    v_subrev_u32 v70, 0x10000, v70
    v_subrev_u32 v71, 0x10000, v71
    s_waitcnt lgkmcnt(0)
    ds_read_b64_tr_b16 v[136:137], v64 offset:0
    ds_read_b64_tr_b16 v[140:141], v65 offset:0
    ds_read_b64_tr_b16 v[144:145], v66 offset:0
    ds_read_b64_tr_b16 v[148:149], v67 offset:0
    ds_read_b64_tr_b16 v[152:153], v68 offset:0
    ds_read_b64_tr_b16 v[156:157], v69 offset:0
    ds_read_b64_tr_b16 v[160:161], v70 offset:0
    ds_read_b64_tr_b16 v[164:165], v71 offset:0
    s_add_u32 s82, s81, 28
    s_and_b32 s82, s82, 31
    s_lshl_b32 s82, s82, 12
    s_add_u32 s82, s82, s80
    s_add_u32 m0, s90, 0x3000
    s_waitcnt vmcnt(7)
    buffer_load_dwordx4 v4, s[40:43], s82 offen offset:0 nt lds
    s_waitcnt vmcnt(7)
    buffer_load_dwordx4 v5, s[40:43], s82 offen offset:1024 nt lds
    s_waitcnt vmcnt(7)
    buffer_load_dwordx4 v6, s[40:43], s82 offen offset:2048 nt lds
    s_waitcnt vmcnt(7)
    buffer_load_dwordx4 v7, s[40:43], s82 offen offset:3072 nt lds
    s_waitcnt lgkmcnt(0)
    ds_read_b64_tr_b16 v[138:139], v64 offset:4096
    ds_read_b64_tr_b16 v[142:143], v65 offset:4096
    ds_read_b64_tr_b16 v[146:147], v66 offset:4096
    ds_read_b64_tr_b16 v[150:151], v67 offset:4096
    ds_read_b64_tr_b16 v[154:155], v68 offset:4096
    ds_read_b64_tr_b16 v[158:159], v69 offset:4096
    ds_read_b64_tr_b16 v[162:163], v70 offset:4096
    ds_read_b64_tr_b16 v[166:167], v71 offset:4096
V_vd:
    v_bfe_u32 v3, v1, 4, 2
    v_lshlrev_b32 v3, 6, v3
    v_bfe_u32 v4, v1, 0, 2
    v_lshl_add_u32 v3, v4, 4, v3
    v_add_u32 v3, s84, v3
    s_mov_b32 s78, 400000
P_162:
    ds_read_b128 v[8:11], v3 offset:7168
    ds_read_b128 v[12:15], v3 offset:7424
    ds_read_b128 v[16:19], v3 offset:7680
    ds_read_b128 v[20:23], v3 offset:7936
    s_waitcnt lgkmcnt(0)
    v_max3_u32 v4, v8, v9, v10
    v_max3_u32 v4, v4, v11, v12
    v_max3_u32 v4, v4, v13, v14
    v_max3_u32 v4, v4, v15, v16
    v_max3_u32 v4, v4, v17, v18
    v_max3_u32 v4, v4, v19, v20
    v_max3_u32 v4, v4, v21, v22
    v_max_u32 v4, v4, v23
    v_cmp_eq_u32 vcc, -1, v4
    s_cbranch_vccz PD_161
    s_sub_u32 s78, s78, 1
    s_cbranch_scc0 P_162
PD_161:
    s_nop 0
    v_mov_b32_dpp v32, v8 quad_perm:[0,1,2,3] row_mask:0xf bank_mask:0x1
    v_mov_b32_dpp v33, v9 quad_perm:[0,1,2,3] row_mask:0xf bank_mask:0x1
    v_mov_b32_dpp v34, v10 quad_perm:[0,1,2,3] row_mask:0xf bank_mask:0x1
    v_mov_b32_dpp v35, v11 quad_perm:[0,1,2,3] row_mask:0xf bank_mask:0x1
    v_mov_b32_dpp v36, v8 quad_perm:[0,1,2,3] row_mask:0xf bank_mask:0x2
    v_mov_b32_dpp v37, v9 quad_perm:[0,1,2,3] row_mask:0xf bank_mask:0x2
    v_mov_b32_dpp v38, v10 quad_perm:[0,1,2,3] row_mask:0xf bank_mask:0x2
    v_mov_b32_dpp v39, v11 quad_perm:[0,1,2,3] row_mask:0xf bank_mask:0x2
    v_mov_b32_dpp v40, v8 quad_perm:[0,1,2,3] row_mask:0xf bank_mask:0x4
    v_mov_b32_dpp v41, v9 quad_perm:[0,1,2,3] row_mask:0xf bank_mask:0x4
    v_mov_b32_dpp v42, v10 quad_perm:[0,1,2,3] row_mask:0xf bank_mask:0x4
    v_mov_b32_dpp v43, v11 quad_perm:[0,1,2,3] row_mask:0xf bank_mask:0x4
    v_mov_b32_dpp v44, v8 quad_perm:[0,1,2,3] row_mask:0xf bank_mask:0x8
    v_mov_b32_dpp v45, v9 quad_perm:[0,1,2,3] row_mask:0xf bank_mask:0x8
    v_mov_b32_dpp v46, v10 quad_perm:[0,1,2,3] row_mask:0xf bank_mask:0x8
    v_mov_b32_dpp v47, v11 quad_perm:[0,1,2,3] row_mask:0xf bank_mask:0x8
    v_mfma_f32_16x16x32_bf16 v[24:27], v[32:35], v[72:75], 0
    v_mov_b32_dpp v48, v12 quad_perm:[0,1,2,3] row_mask:0xf bank_mask:0x1
    v_mov_b32_dpp v49, v13 quad_perm:[0,1,2,3] row_mask:0xf bank_mask:0x1
    v_mfma_f32_16x16x32_bf16 v[24:27], v[36:39], v[76:79], v[24:27]
    v_mov_b32_dpp v50, v14 quad_perm:[0,1,2,3] row_mask:0xf bank_mask:0x1
    v_mov_b32_dpp v51, v15 quad_perm:[0,1,2,3] row_mask:0xf bank_mask:0x1
    v_mfma_f32_16x16x32_bf16 v[24:27], v[40:43], v[80:83], v[24:27]
    v_mov_b32_dpp v52, v12 quad_perm:[0,1,2,3] row_mask:0xf bank_mask:0x2
    v_mov_b32_dpp v53, v13 quad_perm:[0,1,2,3] row_mask:0xf bank_mask:0x2
    v_mfma_f32_16x16x32_bf16 v[24:27], v[44:47], v[84:87], v[24:27]
    v_mov_b32_dpp v54, v14 quad_perm:[0,1,2,3] row_mask:0xf bank_mask:0x2
    v_mov_b32_dpp v55, v15 quad_perm:[0,1,2,3] row_mask:0xf bank_mask:0x2
    v_mfma_f32_16x16x32_bf16 v[28:31], v[32:35], v[88:91], 0
    v_mov_b32_dpp v56, v12 quad_perm:[0,1,2,3] row_mask:0xf bank_mask:0x4
    v_mov_b32_dpp v57, v13 quad_perm:[0,1,2,3] row_mask:0xf bank_mask:0x4
    v_mfma_f32_16x16x32_bf16 v[28:31], v[36:39], v[92:95], v[28:31]
    v_mov_b32_dpp v58, v14 quad_perm:[0,1,2,3] row_mask:0xf bank_mask:0x4
    v_mov_b32_dpp v59, v15 quad_perm:[0,1,2,3] row_mask:0xf bank_mask:0x4
    v_mfma_f32_16x16x32_bf16 v[28:31], v[40:43], v[96:99], v[28:31]
    v_mov_b32_dpp v60, v12 quad_perm:[0,1,2,3] row_mask:0xf bank_mask:0x8
    v_mov_b32_dpp v61, v13 quad_perm:[0,1,2,3] row_mask:0xf bank_mask:0x8
    v_mfma_f32_16x16x32_bf16 v[28:31], v[44:47], v[100:103], v[28:31]
    v_mov_b32_dpp v62, v14 quad_perm:[0,1,2,3] row_mask:0xf bank_mask:0x8
    v_mov_b32_dpp v63, v15 quad_perm:[0,1,2,3] row_mask:0xf bank_mask:0x8
    v_mfma_f32_16x16x32_bf16 v[24:27], v[48:51], v[104:107], v[24:27]
    v_mov_b32_dpp v32, v16 quad_perm:[0,1,2,3] row_mask:0xf bank_mask:0x1
    v_mov_b32_dpp v33, v17 quad_perm:[0,1,2,3] row_mask:0xf bank_mask:0x1
    v_mfma_f32_16x16x32_bf16 v[24:27], v[52:55], v[108:111], v[24:27]
    v_mov_b32_dpp v34, v18 quad_perm:[0,1,2,3] row_mask:0xf bank_mask:0x1
    v_mov_b32_dpp v35, v19 quad_perm:[0,1,2,3] row_mask:0xf bank_mask:0x1
    v_mfma_f32_16x16x32_bf16 v[24:27], v[56:59], v[112:115], v[24:27]
    v_mov_b32_dpp v36, v16 quad_perm:[0,1,2,3] row_mask:0xf bank_mask:0x2
    v_mov_b32_dpp v37, v17 quad_perm:[0,1,2,3] row_mask:0xf bank_mask:0x2
    v_mfma_f32_16x16x32_bf16 v[24:27], v[60:63], v[116:119], v[24:27]
    v_mov_b32_dpp v38, v18 quad_perm:[0,1,2,3] row_mask:0xf bank_mask:0x2
    v_mov_b32_dpp v39, v19 quad_perm:[0,1,2,3] row_mask:0xf bank_mask:0x2
    v_mfma_f32_16x16x32_bf16 v[28:31], v[48:51], v[120:123], v[28:31]
    v_mov_b32_dpp v40, v16 quad_perm:[0,1,2,3] row_mask:0xf bank_mask:0x4
    v_mov_b32_dpp v41, v17 quad_perm:[0,1,2,3] row_mask:0xf bank_mask:0x4
    v_mfma_f32_16x16x32_bf16 v[28:31], v[52:55], v[124:127], v[28:31]
    v_mov_b32_dpp v42, v18 quad_perm:[0,1,2,3] row_mask:0xf bank_mask:0x4
    v_mov_b32_dpp v43, v19 quad_perm:[0,1,2,3] row_mask:0xf bank_mask:0x4
    v_mfma_f32_16x16x32_bf16 v[28:31], v[56:59], v[128:131], v[28:31]
    v_mov_b32_dpp v44, v16 quad_perm:[0,1,2,3] row_mask:0xf bank_mask:0x8
    v_mov_b32_dpp v45, v17 quad_perm:[0,1,2,3] row_mask:0xf bank_mask:0x8
    v_mfma_f32_16x16x32_bf16 v[28:31], v[60:63], v[132:135], v[28:31]
    v_mov_b32_dpp v46, v18 quad_perm:[0,1,2,3] row_mask:0xf bank_mask:0x8
    v_mov_b32_dpp v47, v19 quad_perm:[0,1,2,3] row_mask:0xf bank_mask:0x8
    v_mfma_f32_16x16x32_bf16 v[24:27], v[32:35], v[136:139], v[24:27]
    v_mov_b32_dpp v48, v20 quad_perm:[0,1,2,3] row_mask:0xf bank_mask:0x1
    v_mov_b32_dpp v49, v21 quad_perm:[0,1,2,3] row_mask:0xf bank_mask:0x1
    v_mfma_f32_16x16x32_bf16 v[24:27], v[36:39], v[140:143], v[24:27]
    v_mov_b32_dpp v50, v22 quad_perm:[0,1,2,3] row_mask:0xf bank_mask:0x1
    v_mov_b32_dpp v51, v23 quad_perm:[0,1,2,3] row_mask:0xf bank_mask:0x1
    v_mfma_f32_16x16x32_bf16 v[24:27], v[40:43], v[144:147], v[24:27]
    v_mov_b32_dpp v52, v20 quad_perm:[0,1,2,3] row_mask:0xf bank_mask:0x2
    v_mov_b32_dpp v53, v21 quad_perm:[0,1,2,3] row_mask:0xf bank_mask:0x2
    v_mfma_f32_16x16x32_bf16 v[24:27], v[44:47], v[148:151], v[24:27]
    v_mov_b32_dpp v54, v22 quad_perm:[0,1,2,3] row_mask:0xf bank_mask:0x2
    v_mov_b32_dpp v55, v23 quad_perm:[0,1,2,3] row_mask:0xf bank_mask:0x2
    v_mfma_f32_16x16x32_bf16 v[28:31], v[32:35], v[152:155], v[28:31]
    v_mov_b32_dpp v56, v20 quad_perm:[0,1,2,3] row_mask:0xf bank_mask:0x4
    v_mov_b32_dpp v57, v21 quad_perm:[0,1,2,3] row_mask:0xf bank_mask:0x4
    v_mfma_f32_16x16x32_bf16 v[28:31], v[36:39], v[156:159], v[28:31]
    v_mov_b32_dpp v58, v22 quad_perm:[0,1,2,3] row_mask:0xf bank_mask:0x4
    v_mov_b32_dpp v59, v23 quad_perm:[0,1,2,3] row_mask:0xf bank_mask:0x4
    v_mfma_f32_16x16x32_bf16 v[28:31], v[40:43], v[160:163], v[28:31]
    v_mov_b32_dpp v60, v20 quad_perm:[0,1,2,3] row_mask:0xf bank_mask:0x8
    v_mov_b32_dpp v61, v21 quad_perm:[0,1,2,3] row_mask:0xf bank_mask:0x8
    v_mfma_f32_16x16x32_bf16 v[28:31], v[44:47], v[164:167], v[28:31]
    v_mov_b32_dpp v62, v22 quad_perm:[0,1,2,3] row_mask:0xf bank_mask:0x8
    v_mov_b32_dpp v63, v23 quad_perm:[0,1,2,3] row_mask:0xf bank_mask:0x8
    s_lshl_b32 s91, s76, 11
    v_add_u32 v3, s91, v2
    s_waitcnt vmcnt(4)
    ds_read_b64_tr_b16 v[72:73], v64 offset:8192
    ds_read_b64_tr_b16 v[76:77], v65 offset:8192
    ds_read_b64_tr_b16 v[80:81], v66 offset:8192
    ds_read_b64_tr_b16 v[84:85], v67 offset:8192
    ds_read_b64_tr_b16 v[88:89], v68 offset:8192
    ds_read_b64_tr_b16 v[92:93], v69 offset:8192
    ds_read_b64_tr_b16 v[96:97], v70 offset:8192
    ds_read_b64_tr_b16 v[100:101], v71 offset:8192
    s_waitcnt vmcnt(0)
    s_waitcnt lgkmcnt(0)
    ds_read_b64_tr_b16 v[74:75], v64 offset:12288
    ds_read_b64_tr_b16 v[78:79], v65 offset:12288
    ds_read_b64_tr_b16 v[82:83], v66 offset:12288
    ds_read_b64_tr_b16 v[86:87], v67 offset:12288
    ds_read_b64_tr_b16 v[90:91], v68 offset:12288
    ds_read_b64_tr_b16 v[94:95], v69 offset:12288
    ds_read_b64_tr_b16 v[98:99], v70 offset:12288
    ds_read_b64_tr_b16 v[102:103], v71 offset:12288
    s_waitcnt lgkmcnt(7)
    v_mfma_f32_16x16x32_bf16 v[24:27], v[48:51], v[72:75], v[24:27]
    s_waitcnt lgkmcnt(6)
    v_mfma_f32_16x16x32_bf16 v[24:27], v[52:55], v[76:79], v[24:27]
    s_waitcnt lgkmcnt(5)
    v_mfma_f32_16x16x32_bf16 v[24:27], v[56:59], v[80:83], v[24:27]
    s_waitcnt lgkmcnt(4)
    v_mfma_f32_16x16x32_bf16 v[24:27], v[60:63], v[84:87], v[24:27]
    s_waitcnt lgkmcnt(3)
    v_mfma_f32_16x16x32_bf16 v[28:31], v[48:51], v[88:91], v[28:31]
    s_waitcnt lgkmcnt(2)
    v_mfma_f32_16x16x32_bf16 v[28:31], v[52:55], v[92:95], v[28:31]
    s_waitcnt lgkmcnt(1)
    v_mfma_f32_16x16x32_bf16 v[28:31], v[56:59], v[96:99], v[28:31]
    s_waitcnt lgkmcnt(0)
    v_mfma_f32_16x16x32_bf16 v[28:31], v[60:63], v[100:103], v[28:31]
    ds_write_b128 v3, v[24:27] offset:12288
    s_nop 6
    ds_write_b128 v3, v[28:31] offset:13312
    s_branch L_fin
SLOW_48:
    buffer_store_dwordx2 v[16:17], v6, s[32:35], s59 offen sc1
    s_branch BACK_49
SLOW_53:
    buffer_store_dword v24, v8, s[32:35], s57 offen sc1
    buffer_store_dword v25, v8, s[32:35], s57 offen offset:128 sc1
    s_branch BACK_54
SLOW_89:
    buffer_store_dwordx2 v[16:17], v6, s[32:35], s59 offen sc1
    s_branch BACK_90
SLOW_102:
    buffer_store_dword v40, v132, s[32:35], s66 offen sc1
    s_branch BACK_103
SLOW_135:
    buffer_store_dwordx2 v[18:19], v4, s[32:35], s81 offen sc1
    s_branch BACK_136
L_fin:
L_end:
    s_endpgm
.section .rodata,"a"
.p2align 6
.amdhsa_kernel adaLN_cond__sliding_block_cached__geglu_ffn__decode_kernel
  .amdhsa_next_free_vgpr 168
  .amdhsa_next_free_sgpr 102
  .amdhsa_accum_offset 168
  .amdhsa_group_segment_fixed_size 0
  .amdhsa_kernarg_size 112
  .amdhsa_user_sgpr_count 2
  .amdhsa_user_sgpr_kernarg_segment_ptr 1
  .amdhsa_system_sgpr_workgroup_id_x 1
.end_amdhsa_kernel
```
